```python
import torch

def _softmax(x, axis=-1):
    return torch.softmax(x, dim=axis)
def _gelu(x):
    return torch.nn.functional.gelu(x, approximate="tanh")
def _silu(x):
    return torch.nn.functional.silu(x)
def _sigmoid(x):
    return torch.sigmoid(x)
def _layernorm(x, axis=-1, eps=1e-5):
    m = x.mean(dim=axis, keepdim=True)
    v = x.var(dim=axis, keepdim=True, unbiased=False)
    return (x - m) / torch.sqrt(v + eps)
def _scatter_add(tgt, idx, src, axis=0):
    return tgt.clone().index_add_(axis, idx, src)
def _segment_sum(src, seg, n):
    out = torch.zeros((n,) + src.shape[1:], dtype=src.dtype)
    return out.index_add_(0, seg, src)
def _pad(x, pw):
    flat = tuple(v for pair in reversed(pw) for v in pair)
    return torch.nn.functional.pad(x, flat)

kernel_name = 'gated_mix__grouped_kv_mqa__mixer_token_mlp__prompt'

def setup_inputs():

    _w = (lambda a: (lambda t: t.to(torch.bfloat16) if t.is_floating_point() else t)(torch.as_tensor(a)))
    def _A_setup():
        B, S, D, H = 1, 2048, 448, 16
        Dh = D // H
        return {
            "x": _w((lambda *s: torch.randn(*s, dtype=torch.bfloat16) * 0.05)(B, S, D)),
            "wq": _w((lambda *s: torch.randn(*s, dtype=torch.bfloat16) * 1.6)(D, H * Dh)),
            "wk": _w((lambda *s: torch.randn(*s, dtype=torch.bfloat16) * 1.6)(D, Dh)),
            "wv": _w((lambda *s: torch.randn(*s, dtype=torch.bfloat16) * 0.05)(D, Dh)),
            "wo": _w((lambda *s: torch.randn(*s, dtype=torch.bfloat16) * 0.05)(H * Dh, D)),
        }
    _A_in = _A_setup()

    def _B_setup():
        B, S, D, F = 1, 2048, 448, 1792
        return {
            "x": _w((lambda *s: torch.randn(*s, dtype=torch.bfloat16) * 0.05)(B, S, D)),
            "w1": _w((lambda *s: torch.randn(*s, dtype=torch.bfloat16) * 0.8)(S, F) * (S ** -0.5)),
            "b1": _w((lambda *s: torch.randn(*s, dtype=torch.bfloat16) * 12.8)(F) * 0.02),
            "w2": _w((lambda *s: torch.randn(*s, dtype=torch.bfloat16) * 0.05)(F, S) * (F ** -0.5)),
            "b2": _w((lambda *s: torch.randn(*s, dtype=torch.bfloat16) * 0.4)(S) * 0.02),
        }
    _B_in = _B_setup()

    return {
        "A_x": _A_in["x"],
        "A_wq": _A_in["wq"],
        "A_wk": _A_in["wk"],
        "A_wv": _A_in["wv"],
        "A_wo": _A_in["wo"],
        "B_x": _B_in["x"],
        "B_w1": _B_in["w1"],
        "B_b1": _B_in["b1"],
        "B_w2": _B_in["w2"],
        "B_b2": _B_in["b2"],
        "gate_w": _w((lambda *s: torch.randn(*s, dtype=torch.bfloat16) * 0.05)(448) * 16.0),
    }

def reference(A_x, A_wq, A_wk, A_wv, A_wo, B_x, B_w1, B_b1, B_w2, B_b2, gate_w):
    def _A_ref(x, wq, wk, wv, wo):
        B, S, D = x.shape
        H = 16
        Dh = D // H
        q = (lambda x, *d: x.permute(*d))((x @ wq).reshape(B, S, H, Dh), 0, 2, 1, 3)
        k = x @ wk
        v = x @ wv
        scores = torch.einsum("bhqd,bkd->bhqk", q, k) * (Dh ** -0.5)
        p = _softmax(scores, axis=-1)
        o = torch.einsum("bhqk,bkd->bhqd", p, v)
        return (lambda x, *d: x.permute(*d))(o, 0, 2, 1, 3).reshape(B, S, H * Dh) @ wo

    def _B_ref(x, w1, b1, w2, b2):
        B, S, D = x.shape
        h = _layernorm(x, axis=-1)
        u = torch.einsum("bsd,sf->bdf", h, w1) + b1
        u = _gelu(u)
        y = torch.einsum("bdf,fs->bds", u, w2) + b2
        return (lambda x, *d: x.permute(*d))(y, 0, 2, 1)

    x = A_x
    g = _sigmoid((x * gate_w).sum(-1, keepdims=True))
    a = _A_ref(x, A_wq, A_wk, A_wv, A_wo)
    b = _B_ref(x, B_w1, B_b1, B_w2, B_b2)
    return g * a + (1 - g) * b
```

```asm
; @launch grid=(256,1,1) block=(512,1,1) lds=162944
.amdgcn_target "amdgcn-amd-amdhsa--gfx950"
.text
.globl gated_mix__grouped_kv_mqa__mixer_token_mlp__prompt_kernel
.p2align 8
.type gated_mix__grouped_kv_mqa__mixer_token_mlp__prompt_kernel,@function
gated_mix__grouped_kv_mqa__mixer_token_mlp__prompt_kernel:
 s_cmp_ge_u32 s2, 256
 s_cbranch_scc1 L_end
 s_load_dword s8, s[0:1], 0
 s_load_dword s9, s[0:1], 104
 v_lshrrev_b32 v1, 6, v0
 s_and_b32 s3, s2, 31
 v_readfirstlane_b32 s5, v1
 s_lshr_b32 s4, s2, 5
 v_and_b32 v1, 63, v0
 v_lshrrev_b32 v2, 5, v1
 v_and_b32 v3, 31, v1
 v_bfe_u32 v4, v1, 2, 2
 v_and_b32 v5, 16, v1
 v_and_b32 v6, 3, v1
 v_lshlrev_b32 v5, 1, v5
 v_lshl_add_u32 v5, v6, 3, v5
 v_and_b32 v7, 15, v1
 v_lshlrev_b32 v7, 2, v7
 v_add_u32 v7, 162816, v7
 v_mov_b32 v8, 0
 ds_write_b32 v7, v8
 s_waitcnt lgkmcnt(0)
 s_barrier
 s_cmp_ge_u32 s5, 4
 s_cbranch_scc1 L_g
 s_load_dwordx2 s[8:9], s[0:1], 0
 s_load_dwordx2 s[56:57], s[0:1], 96
 s_load_dwordx2 s[16:17], s[0:1], 8
 s_load_dwordx2 s[12:13], s[0:1], 104
 s_load_dwordx2 s[20:21], s[0:1], 48
 s_mov_b32 s10, 1835008
 s_mov_b32 s11, 0x20000
 s_mov_b32 s58, 256
 s_mov_b32 s59, 0x20000
 s_mov_b32 s18, 401408
 s_mov_b32 s19, 0x20000
 s_mov_b32 s14, 9961472
 s_mov_b32 s15, 0x20000
 s_mov_b32 s22, 7340032
 s_mov_b32 s23, 0x20000
 s_memrealtime s[60:61]
 s_or_b32 s6, s2, s5
 s_waitcnt lgkmcnt(0)
 s_cmp_eq_u32 s6, 0
 s_cbranch_scc0 L_nononce
 s_or_b32 s60, s60, 1
 s_waitcnt vmcnt(0)
 s_mov_b64 exec, 1
 v_mov_b32 v8, 0
 v_mov_b32 v9, s60
 buffer_store_dword v9, v8, s[56:59], 0 offen offset:0 sc1
 s_mov_b64 exec, -1
L_nononce:
 buffer_load_dword v255, v8, s[56:59], 0 offen offset:0 sc1
 s_setprio 2
 s_lshl_b32 s6, s4, 2
 s_add_u32 s6, s6, s5
 s_mul_i32 s6, s6, 1792
 s_mul_i32 s7, s3, 57344
 s_add_u32 s6, s6, s7
 v_min_u32 v7, 13, v1
 v_lshlrev_b32 v7, 7, v7
 s_lshr_b32 s7, s2, 3
 s_lshl_b32 s7, s7, 2
 s_add_u32 s7, s7, s5
 s_mul_i32 s7, s7, 25
 v_min_u32 v9, 24, v1
 v_add_u32 v9, s7, v9
 v_min_u32 v9, 3135, v9
 v_lshlrev_b32 v9, 7, v9
 buffer_load_dword v253, v7, s[8:11], s6 offen offset:0
 buffer_load_dword v252, v9, s[16:19], 0 offen offset:0
 s_mul_i32 s6, s3, 57344
 s_mul_i32 s7, s5, 14336
 s_add_u32 s6, s6, s7
 s_mov_b32 m0, s7
 v_add_u32 v7, 0, v1
 v_mul_u32_u24 v8, 1171, v7
 v_lshrrev_b32 v8, 17, v8
 v_xor_b32 v7, v7, v8
 v_lshlrev_b32 v7, 4, v7
 buffer_load_dwordx4 v7, s[8:11], s6 offen offset:0  lds
 s_add_u32 m0, m0, 1024
 v_add_u32 v7, 64, v1
 v_mul_u32_u24 v8, 1171, v7
 v_lshrrev_b32 v8, 17, v8
 v_xor_b32 v7, v7, v8
 v_lshlrev_b32 v7, 4, v7
 buffer_load_dwordx4 v7, s[8:11], s6 offen offset:0  lds
 s_add_u32 m0, m0, 1024
 v_add_u32 v7, 128, v1
 v_mul_u32_u24 v8, 1171, v7
 v_lshrrev_b32 v8, 17, v8
 v_xor_b32 v7, v7, v8
 v_lshlrev_b32 v7, 4, v7
 buffer_load_dwordx4 v7, s[8:11], s6 offen offset:0  lds
 s_add_u32 m0, m0, 1024
 v_add_u32 v7, 192, v1
 v_mul_u32_u24 v8, 1171, v7
 v_lshrrev_b32 v8, 17, v8
 v_xor_b32 v7, v7, v8
 v_lshlrev_b32 v7, 4, v7
 buffer_load_dwordx4 v7, s[8:11], s6 offen offset:0  lds
 s_add_u32 m0, m0, 1024
 v_add_u32 v7, 256, v1
 v_mul_u32_u24 v8, 1171, v7
 v_lshrrev_b32 v8, 17, v8
 v_xor_b32 v7, v7, v8
 v_lshlrev_b32 v7, 4, v7
 buffer_load_dwordx4 v7, s[8:11], s6 offen offset:0  lds
 s_add_u32 m0, m0, 1024
 v_add_u32 v7, 320, v1
 v_mul_u32_u24 v8, 1171, v7
 v_lshrrev_b32 v8, 17, v8
 v_xor_b32 v7, v7, v8
 v_lshlrev_b32 v7, 4, v7
 buffer_load_dwordx4 v7, s[8:11], s6 offen offset:0  lds
 s_add_u32 m0, m0, 1024
 v_add_u32 v7, 384, v1
 v_mul_u32_u24 v8, 1171, v7
 v_lshrrev_b32 v8, 17, v8
 v_xor_b32 v7, v7, v8
 v_lshlrev_b32 v7, 4, v7
 buffer_load_dwordx4 v7, s[8:11], s6 offen offset:0  lds
 s_add_u32 m0, m0, 1024
 v_add_u32 v7, 448, v1
 v_mul_u32_u24 v8, 1171, v7
 v_lshrrev_b32 v8, 17, v8
 v_xor_b32 v7, v7, v8
 v_lshlrev_b32 v7, 4, v7
 buffer_load_dwordx4 v7, s[8:11], s6 offen offset:0  lds
 s_add_u32 m0, m0, 1024
 v_add_u32 v7, 512, v1
 v_mul_u32_u24 v8, 1171, v7
 v_lshrrev_b32 v8, 17, v8
 v_xor_b32 v7, v7, v8
 v_lshlrev_b32 v7, 4, v7
 buffer_load_dwordx4 v7, s[8:11], s6 offen offset:0  lds
 s_add_u32 m0, m0, 1024
 v_add_u32 v7, 576, v1
 v_mul_u32_u24 v8, 1171, v7
 v_lshrrev_b32 v8, 17, v8
 v_xor_b32 v7, v7, v8
 v_lshlrev_b32 v7, 4, v7
 buffer_load_dwordx4 v7, s[8:11], s6 offen offset:0  lds
 s_add_u32 m0, m0, 1024
 v_add_u32 v7, 640, v1
 v_mul_u32_u24 v8, 1171, v7
 v_lshrrev_b32 v8, 17, v8
 v_xor_b32 v7, v7, v8
 v_lshlrev_b32 v7, 4, v7
 buffer_load_dwordx4 v7, s[8:11], s6 offen offset:0  lds
 s_add_u32 m0, m0, 1024
 v_add_u32 v7, 704, v1
 v_mul_u32_u24 v8, 1171, v7
 v_lshrrev_b32 v8, 17, v8
 v_xor_b32 v7, v7, v8
 v_lshlrev_b32 v7, 4, v7
 buffer_load_dwordx4 v7, s[8:11], s6 offen offset:0  lds
 s_add_u32 m0, m0, 1024
 v_add_u32 v7, 768, v1
 v_mul_u32_u24 v8, 1171, v7
 v_lshrrev_b32 v8, 17, v8
 v_xor_b32 v7, v7, v8
 v_lshlrev_b32 v7, 4, v7
 buffer_load_dwordx4 v7, s[8:11], s6 offen offset:0  lds
 s_add_u32 m0, m0, 1024
 v_add_u32 v7, 832, v1
 v_mul_u32_u24 v8, 1171, v7
 v_lshrrev_b32 v8, 17, v8
 v_xor_b32 v7, v7, v8
 v_lshlrev_b32 v7, 4, v7
 buffer_load_dwordx4 v7, s[8:11], s6 offen offset:0  lds
 s_add_u32 m0, m0, 1024
 s_cmp_eq_u32 s4, 7
 s_cbranch_scc0 L_nodlk
 s_waitcnt vmcnt(0)
 s_waitcnt lgkmcnt(0)
 s_mov_b64 exec, 1
 v_mov_b32 v8, 162872
 v_mov_b32 v9, 1
 ds_add_u32 v8, v9
 s_mov_b64 exec, -1
 v_mov_b32 v8, 162868
 s_mov_b32 s43, 0x400000
L_ll1:
 ds_read_b32 v9, v8
 s_waitcnt lgkmcnt(0)
 v_cmp_gt_u32 vcc, 4, v9
 s_sub_u32 s43, s43, 1
 s_cbranch_scc1 L_ld1
 s_cbranch_vccz L_ld1
 s_sleep 1
 s_branch L_ll1
L_ld1:
L_nodlk:
 s_mul_i32 s7, s5, 12288
 s_add_u32 m0, s7, 57344
 s_mul_i32 s6, s4, 112
 s_mul_i32 s7, s5, 768
 v_add_u32 v9, s7, v1
 v_add_u32 v7, 0, v9
 v_mul_u32_u24 v8, 9363, v7
 v_lshrrev_b32 v8, 16, v8
 v_mul_u32_u24 v8, 784, v8
 v_lshl_add_u32 v7, v7, 4, v8
 buffer_load_dwordx4 v7, s[16:19], s6 offen offset:0  lds
 s_add_u32 m0, m0, 1024
 v_add_u32 v7, 64, v9
 v_mul_u32_u24 v8, 9363, v7
 v_lshrrev_b32 v8, 16, v8
 v_mul_u32_u24 v8, 784, v8
 v_lshl_add_u32 v7, v7, 4, v8
 buffer_load_dwordx4 v7, s[16:19], s6 offen offset:0  lds
 s_add_u32 m0, m0, 1024
 v_add_u32 v7, 128, v9
 v_mul_u32_u24 v8, 9363, v7
 v_lshrrev_b32 v8, 16, v8
 v_mul_u32_u24 v8, 784, v8
 v_lshl_add_u32 v7, v7, 4, v8
 buffer_load_dwordx4 v7, s[16:19], s6 offen offset:0  lds
 s_add_u32 m0, m0, 1024
 v_add_u32 v7, 192, v9
 v_mul_u32_u24 v8, 9363, v7
 v_lshrrev_b32 v8, 16, v8
 v_mul_u32_u24 v8, 784, v8
 v_lshl_add_u32 v7, v7, 4, v8
 buffer_load_dwordx4 v7, s[16:19], s6 offen offset:0  lds
 s_add_u32 m0, m0, 1024
 v_add_u32 v7, 256, v9
 v_mul_u32_u24 v8, 9363, v7
 v_lshrrev_b32 v8, 16, v8
 v_mul_u32_u24 v8, 784, v8
 v_lshl_add_u32 v7, v7, 4, v8
 buffer_load_dwordx4 v7, s[16:19], s6 offen offset:0  lds
 s_add_u32 m0, m0, 1024
 v_add_u32 v7, 320, v9
 v_mul_u32_u24 v8, 9363, v7
 v_lshrrev_b32 v8, 16, v8
 v_mul_u32_u24 v8, 784, v8
 v_lshl_add_u32 v7, v7, 4, v8
 buffer_load_dwordx4 v7, s[16:19], s6 offen offset:0  lds
 s_add_u32 m0, m0, 1024
 v_add_u32 v7, 384, v9
 v_mul_u32_u24 v8, 9363, v7
 v_lshrrev_b32 v8, 16, v8
 v_mul_u32_u24 v8, 784, v8
 v_lshl_add_u32 v7, v7, 4, v8
 buffer_load_dwordx4 v7, s[16:19], s6 offen offset:0  lds
 s_add_u32 m0, m0, 1024
 v_add_u32 v7, 448, v9
 v_mul_u32_u24 v8, 9363, v7
 v_lshrrev_b32 v8, 16, v8
 v_mul_u32_u24 v8, 784, v8
 v_lshl_add_u32 v7, v7, 4, v8
 buffer_load_dwordx4 v7, s[16:19], s6 offen offset:0  lds
 s_add_u32 m0, m0, 1024
 v_add_u32 v7, 512, v9
 v_mul_u32_u24 v8, 9363, v7
 v_lshrrev_b32 v8, 16, v8
 v_mul_u32_u24 v8, 784, v8
 v_lshl_add_u32 v7, v7, 4, v8
 buffer_load_dwordx4 v7, s[16:19], s6 offen offset:0  lds
 s_add_u32 m0, m0, 1024
 v_add_u32 v7, 576, v9
 v_mul_u32_u24 v8, 9363, v7
 v_lshrrev_b32 v8, 16, v8
 v_mul_u32_u24 v8, 784, v8
 v_lshl_add_u32 v7, v7, 4, v8
 buffer_load_dwordx4 v7, s[16:19], s6 offen offset:0  lds
 s_add_u32 m0, m0, 1024
 v_add_u32 v7, 640, v9
 v_mul_u32_u24 v8, 9363, v7
 v_lshrrev_b32 v8, 16, v8
 v_mul_u32_u24 v8, 784, v8
 v_lshl_add_u32 v7, v7, 4, v8
 buffer_load_dwordx4 v7, s[16:19], s6 offen offset:0  lds
 s_add_u32 m0, m0, 1024
 v_add_u32 v7, 704, v9
 v_mul_u32_u24 v8, 9363, v7
 v_lshrrev_b32 v8, 16, v8
 v_mul_u32_u24 v8, 784, v8
 v_lshl_add_u32 v7, v7, 4, v8
 buffer_load_dwordx4 v7, s[16:19], s6 offen offset:0  lds
 s_add_u32 m0, m0, 1024
 v_add_u32 v7, 768, v9
 v_mul_u32_u24 v8, 9363, v7
 v_lshrrev_b32 v8, 16, v8
 v_mul_u32_u24 v8, 784, v8
 v_lshl_add_u32 v7, v7, 4, v8
 buffer_load_dwordx4 v7, s[16:19], s6 offen offset:0  lds
 s_add_u32 m0, m0, 1024
 s_and_b32 s6, s5, 1
 s_lshr_b32 s7, s5, 1
 s_mul_i32 s7, s7, 56
 v_lshl_add_u32 v7, s6, 5, v3
 v_bfe_u32 v8, v7, 1, 3
 v_mul_u32_u24 v7, 896, v7
 v_or_b32 v9, 0, v2
 v_xor_b32 v9, v9, v8
 v_lshl_add_u32 v10, v9, 4, v7
 v_or_b32 v9, 2, v2
 v_xor_b32 v9, v9, v8
 v_lshl_add_u32 v11, v9, 4, v7
 v_or_b32 v9, 4, v2
 v_xor_b32 v9, v9, v8
 v_lshl_add_u32 v12, v9, 4, v7
 v_or_b32 v9, 6, v2
 v_xor_b32 v9, v9, v8
 v_lshl_add_u32 v13, v9, 4, v7
 v_lshl_add_u32 v14, v2, 3, v4
 v_mul_u32_u24 v14, 112, v14
 v_add3_u32 v14, v14, v5, s7
 v_add_u32 v14, 57344, v14
 s_waitcnt vmcnt(13)
 s_waitcnt lgkmcnt(0)
 s_mov_b64 exec, 1
 v_mov_b32 v8, 162848
 v_mov_b32 v9, 1
 ds_add_u32 v8, v9
 s_mov_b64 exec, -1
 s_waitcnt vmcnt(0)
 s_waitcnt lgkmcnt(0)
 s_mov_b64 exec, 1
 v_mov_b32 v8, 162852
 v_mov_b32 v9, 1
 ds_add_u32 v8, v9
 s_mov_b64 exec, -1
 v_mov_b32 v8, 162852
 s_mov_b32 s43, 0x400000
L_ll2:
 ds_read_b32 v9, v8
 s_waitcnt lgkmcnt(0)
 v_cmp_gt_u32 vcc, 4, v9
 s_sub_u32 s43, s43, 1
 s_cbranch_scc1 L_ld2
 s_cbranch_vccz L_ld2
 s_sleep 1
 s_branch L_ll2
L_ld2:
 ds_read_b128 v[16:19], v10 offset:0
 ds_read_b64_tr_b16 v[20:21], v14 offset:0
 ds_read_b64_tr_b16 v[22:23], v14 offset:448
 ds_read_b128 v[24:27], v11 offset:0
 ds_read_b64_tr_b16 v[28:29], v14 offset:1792
 ds_read_b64_tr_b16 v[30:31], v14 offset:2240
 ds_read_b128 v[32:35], v12 offset:0
 ds_read_b64_tr_b16 v[36:37], v14 offset:3584
 ds_read_b64_tr_b16 v[38:39], v14 offset:4032
 ds_read_b128 v[40:43], v13 offset:0
 ds_read_b64_tr_b16 v[44:45], v14 offset:5376
 ds_read_b64_tr_b16 v[46:47], v14 offset:5824
 s_waitcnt lgkmcnt(9)
 v_mfma_f32_32x32x16_bf16 v[64:79], v[20:23], v[16:19], 0
 ds_read_b128 v[16:19], v10 offset:128
 ds_read_b64_tr_b16 v[20:21], v14 offset:7168
 ds_read_b64_tr_b16 v[22:23], v14 offset:7616
 s_waitcnt lgkmcnt(9)
 v_mfma_f32_32x32x16_bf16 v[64:79], v[28:31], v[24:27], v[64:79]
 ds_read_b128 v[24:27], v11 offset:128
 ds_read_b64_tr_b16 v[28:29], v14 offset:8960
 ds_read_b64_tr_b16 v[30:31], v14 offset:9408
 s_waitcnt lgkmcnt(9)
 v_mfma_f32_32x32x16_bf16 v[64:79], v[36:39], v[32:35], v[64:79]
 ds_read_b128 v[32:35], v12 offset:128
 ds_read_b64_tr_b16 v[36:37], v14 offset:10752
 ds_read_b64_tr_b16 v[38:39], v14 offset:11200
 s_waitcnt lgkmcnt(9)
 v_mfma_f32_32x32x16_bf16 v[64:79], v[44:47], v[40:43], v[64:79]
 ds_read_b128 v[40:43], v13 offset:128
 ds_read_b64_tr_b16 v[44:45], v14 offset:12544
 ds_read_b64_tr_b16 v[46:47], v14 offset:12992
 s_waitcnt lgkmcnt(9)
 v_mfma_f32_32x32x16_bf16 v[64:79], v[20:23], v[16:19], v[64:79]
 ds_read_b128 v[16:19], v10 offset:256
 ds_read_b64_tr_b16 v[20:21], v14 offset:14336
 ds_read_b64_tr_b16 v[22:23], v14 offset:14784
 s_waitcnt lgkmcnt(9)
 v_mfma_f32_32x32x16_bf16 v[64:79], v[28:31], v[24:27], v[64:79]
 ds_read_b128 v[24:27], v11 offset:256
 ds_read_b64_tr_b16 v[28:29], v14 offset:16128
 ds_read_b64_tr_b16 v[30:31], v14 offset:16576
 s_waitcnt lgkmcnt(9)
 v_mfma_f32_32x32x16_bf16 v[64:79], v[36:39], v[32:35], v[64:79]
 ds_read_b128 v[32:35], v12 offset:256
 ds_read_b64_tr_b16 v[36:37], v14 offset:17920
 ds_read_b64_tr_b16 v[38:39], v14 offset:18368
 s_waitcnt lgkmcnt(9)
 v_mfma_f32_32x32x16_bf16 v[64:79], v[44:47], v[40:43], v[64:79]
 ds_read_b128 v[40:43], v13 offset:256
 ds_read_b64_tr_b16 v[44:45], v14 offset:19712
 ds_read_b64_tr_b16 v[46:47], v14 offset:20160
 s_waitcnt lgkmcnt(9)
 v_mfma_f32_32x32x16_bf16 v[64:79], v[20:23], v[16:19], v[64:79]
 ds_read_b128 v[16:19], v10 offset:384
 ds_read_b64_tr_b16 v[20:21], v14 offset:21504
 ds_read_b64_tr_b16 v[22:23], v14 offset:21952
 s_waitcnt lgkmcnt(9)
 v_mfma_f32_32x32x16_bf16 v[64:79], v[28:31], v[24:27], v[64:79]
 ds_read_b128 v[24:27], v11 offset:384
 ds_read_b64_tr_b16 v[28:29], v14 offset:23296
 ds_read_b64_tr_b16 v[30:31], v14 offset:23744
 s_waitcnt lgkmcnt(9)
 v_mfma_f32_32x32x16_bf16 v[64:79], v[36:39], v[32:35], v[64:79]
 ds_read_b128 v[32:35], v12 offset:384
 ds_read_b64_tr_b16 v[36:37], v14 offset:25088
 ds_read_b64_tr_b16 v[38:39], v14 offset:25536
 s_waitcnt lgkmcnt(9)
 v_mfma_f32_32x32x16_bf16 v[64:79], v[44:47], v[40:43], v[64:79]
 ds_read_b128 v[40:43], v13 offset:384
 ds_read_b64_tr_b16 v[44:45], v14 offset:26880
 ds_read_b64_tr_b16 v[46:47], v14 offset:27328
 s_waitcnt lgkmcnt(9)
 v_mfma_f32_32x32x16_bf16 v[64:79], v[20:23], v[16:19], v[64:79]
 ds_read_b128 v[16:19], v10 offset:512
 ds_read_b64_tr_b16 v[20:21], v14 offset:28672
 ds_read_b64_tr_b16 v[22:23], v14 offset:29120
 s_waitcnt lgkmcnt(9)
 v_mfma_f32_32x32x16_bf16 v[64:79], v[28:31], v[24:27], v[64:79]
 ds_read_b128 v[24:27], v11 offset:512
 ds_read_b64_tr_b16 v[28:29], v14 offset:30464
 ds_read_b64_tr_b16 v[30:31], v14 offset:30912
 s_waitcnt lgkmcnt(9)
 v_mfma_f32_32x32x16_bf16 v[64:79], v[36:39], v[32:35], v[64:79]
 ds_read_b128 v[32:35], v12 offset:512
 ds_read_b64_tr_b16 v[36:37], v14 offset:32256
 ds_read_b64_tr_b16 v[38:39], v14 offset:32704
 s_waitcnt lgkmcnt(9)
 v_mfma_f32_32x32x16_bf16 v[64:79], v[44:47], v[40:43], v[64:79]
 ds_read_b128 v[40:43], v13 offset:512
 ds_read_b64_tr_b16 v[44:45], v14 offset:34048
 ds_read_b64_tr_b16 v[46:47], v14 offset:34496
 s_waitcnt lgkmcnt(9)
 v_mfma_f32_32x32x16_bf16 v[64:79], v[20:23], v[16:19], v[64:79]
 ds_read_b128 v[16:19], v10 offset:640
 ds_read_b64_tr_b16 v[20:21], v14 offset:35840
 ds_read_b64_tr_b16 v[22:23], v14 offset:36288
 s_waitcnt lgkmcnt(9)
 v_mfma_f32_32x32x16_bf16 v[64:79], v[28:31], v[24:27], v[64:79]
 ds_read_b128 v[24:27], v11 offset:640
 ds_read_b64_tr_b16 v[28:29], v14 offset:37632
 ds_read_b64_tr_b16 v[30:31], v14 offset:38080
 s_waitcnt lgkmcnt(9)
 v_mfma_f32_32x32x16_bf16 v[64:79], v[36:39], v[32:35], v[64:79]
 ds_read_b128 v[32:35], v12 offset:640
 ds_read_b64_tr_b16 v[36:37], v14 offset:39424
 ds_read_b64_tr_b16 v[38:39], v14 offset:39872
 s_waitcnt lgkmcnt(9)
 v_mfma_f32_32x32x16_bf16 v[64:79], v[44:47], v[40:43], v[64:79]
 ds_read_b128 v[40:43], v13 offset:640
 ds_read_b64_tr_b16 v[44:45], v14 offset:41216
 ds_read_b64_tr_b16 v[46:47], v14 offset:41664
 s_waitcnt lgkmcnt(9)
 v_mfma_f32_32x32x16_bf16 v[64:79], v[20:23], v[16:19], v[64:79]
 ds_read_b128 v[16:19], v10 offset:768
 ds_read_b64_tr_b16 v[20:21], v14 offset:43008
 ds_read_b64_tr_b16 v[22:23], v14 offset:43456
 s_waitcnt lgkmcnt(9)
 v_mfma_f32_32x32x16_bf16 v[64:79], v[28:31], v[24:27], v[64:79]
 ds_read_b128 v[24:27], v11 offset:768
 ds_read_b64_tr_b16 v[28:29], v14 offset:44800
 ds_read_b64_tr_b16 v[30:31], v14 offset:45248
 s_waitcnt lgkmcnt(9)
 v_mfma_f32_32x32x16_bf16 v[64:79], v[36:39], v[32:35], v[64:79]
 ds_read_b128 v[32:35], v12 offset:768
 ds_read_b64_tr_b16 v[36:37], v14 offset:46592
 ds_read_b64_tr_b16 v[38:39], v14 offset:47040
 s_waitcnt lgkmcnt(9)
 v_mfma_f32_32x32x16_bf16 v[64:79], v[44:47], v[40:43], v[64:79]
 ds_read_b128 v[40:43], v13 offset:768
 ds_read_b64_tr_b16 v[44:45], v14 offset:48384
 ds_read_b64_tr_b16 v[46:47], v14 offset:48832
 s_waitcnt lgkmcnt(9)
 v_mfma_f32_32x32x16_bf16 v[64:79], v[20:23], v[16:19], v[64:79]
 s_waitcnt lgkmcnt(6)
 v_mfma_f32_32x32x16_bf16 v[64:79], v[28:31], v[24:27], v[64:79]
 s_waitcnt lgkmcnt(3)
 v_mfma_f32_32x32x16_bf16 v[64:79], v[36:39], v[32:35], v[64:79]
 s_waitcnt lgkmcnt(0)
 v_mfma_f32_32x32x16_bf16 v[64:79], v[44:47], v[40:43], v[64:79]
 s_nop 7
 s_nop 7
 s_waitcnt lgkmcnt(0)
 s_mov_b64 exec, 1
 v_mov_b32 v8, 162856
 v_mov_b32 v9, 1
 ds_add_u32 v8, v9
 s_mov_b64 exec, -1
 v_mul_f32 v64, 0.2726437354213113, v64
 v_mul_f32 v65, 0.2726437354213113, v65
 v_mul_f32 v66, 0.2726437354213113, v66
 v_mul_f32 v67, 0.2726437354213113, v67
 v_mul_f32 v68, 0.2726437354213113, v68
 v_mul_f32 v69, 0.2726437354213113, v69
 v_mul_f32 v70, 0.2726437354213113, v70
 v_mul_f32 v71, 0.2726437354213113, v71
 v_mul_f32 v72, 0.2726437354213113, v72
 v_mul_f32 v73, 0.2726437354213113, v73
 v_mul_f32 v74, 0.2726437354213113, v74
 v_mul_f32 v75, 0.2726437354213113, v75
 v_mul_f32 v76, 0.2726437354213113, v76
 v_mul_f32 v77, 0.2726437354213113, v77
 v_mul_f32 v78, 0.2726437354213113, v78
 v_mul_f32 v79, 0.2726437354213113, v79
 v_cmp_gt_u32 vcc, 32, v1
 v_cvt_pk_bf16_f32 v16, v64, v65
 v_cvt_pk_bf16_f32 v17, v66, v67
 v_cvt_pk_bf16_f32 v18, v68, v69
 v_cvt_pk_bf16_f32 v19, v70, v71
 v_cvt_pk_bf16_f32 v20, v72, v73
 v_cvt_pk_bf16_f32 v21, v74, v75
 v_cvt_pk_bf16_f32 v22, v76, v77
 v_cvt_pk_bf16_f32 v23, v78, v79
 v_cndmask_b32 v22, 0, v22, vcc
 v_cndmask_b32 v23, 0, v23, vcc
 v_lshlrev_b32 v10, 4, v1
 s_lshl_b32 s6, s5, 11
 v_add_u32 v7, s6, v10
 v_mov_b32 v8, 162856
 s_mov_b32 s43, 0x400000
L_ll3:
 ds_read_b32 v9, v8
 s_waitcnt lgkmcnt(0)
 v_cmp_gt_u32 vcc, 4, v9
 s_sub_u32 s43, s43, 1
 s_cbranch_scc1 L_ld3
 s_cbranch_vccz L_ld3
 s_sleep 1
 s_branch L_ll3
L_ld3:
 ds_write_b128 v7, v[16:19] offset:57344
 ds_write_b128 v7, v[20:23] offset:58368
 s_waitcnt lgkmcnt(0)
 s_mov_b64 exec, 1
 v_mov_b32 v8, 162860
 v_mov_b32 v9, 1
 ds_add_u32 v8, v9
 s_mov_b64 exec, -1
 s_mov_b32 s43, 0x40000
 v_mov_b32 v8, 0
L_nl4:
 v_readfirstlane_b32 s60, v255
 s_cmp_lg_u32 s60, 0
 s_cbranch_scc1 L_nd4
 s_sub_u32 s43, s43, 1
 s_cbranch_scc1 L_nd4
 buffer_load_dword v255, v8, s[56:59], 0 offen offset:0 sc1
 s_waitcnt vmcnt(0)
 s_branch L_nl4
L_nd4:
 s_lshl_b32 s6, s5, 12
 v_lshl_add_u32 v12, v3, 7, s6
 v_add_u32 v12, 393216, v12
 s_lshl_b32 s6, s3, 9
 v_lshl_add_u32 v13, v6, 7, s6
 v_add_u32 v13, 262144, v13
 v_mov_b32 v14, 393216
 v_cmp_gt_u32 vcc, 48, v1
 s_nop 1
 v_cndmask_b32 v13, v14, v13, vcc
 v_cmp_gt_u32 vcc, 32, v1
 s_nop 1
 v_cndmask_b32 v12, v13, v12, vcc
 s_mov_b32 s6, 9437184
 v_mov_b32 v8, 162860
 s_mov_b32 s43, 0x400000
L_ll5:
 ds_read_b32 v9, v8
 s_waitcnt lgkmcnt(0)
 v_cmp_gt_u32 vcc, 4, v9
 s_sub_u32 s43, s43, 1
 s_cbranch_scc1 L_ld5
 s_cbranch_vccz L_ld5
 s_sleep 1
 s_branch L_ll5
L_ld5:
 v_xor_b32 v8, 2048, v7
 ds_read_b128 v[24:27], v8 offset:57344
 ds_read_b128 v[28:31], v8 offset:58368
 v_xor_b32 v8, 4096, v7
 ds_read_b128 v[32:35], v8 offset:57344
 ds_read_b128 v[36:39], v8 offset:58368
 v_xor_b32 v8, 6144, v7
 ds_read_b128 v[40:43], v8 offset:57344
 ds_read_b128 v[44:47], v8 offset:58368
 s_mov_b32 s43, 0x40000
L_pl6:
 buffer_load_dword v9, v12, s[12:15], s6 offen offset:0 sc1
 s_waitcnt vmcnt(0)
 v_cmp_ne_u32 vcc, s60, v9
 s_sub_u32 s43, s43, 1
 s_cbranch_scc1 L_pd6
 s_cbranch_vccz L_pd6
 s_mov_b64 exec, vcc
 s_sleep 2
 s_branch L_pl6
L_pd6:
 s_mov_b64 exec, -1
 s_lshl_b32 s31, s5, 16
 s_add_u32 s31, s31, 2097152
 s_lshl_b32 s7, s3, 1
 s_and_b32 s34, s5, 1
 s_add_u32 s7, s7, s34
 v_lshl_add_u32 v7, s7, 5, v3
 v_lshlrev_b32 v7, 2, v7
 s_mov_b32 s34, 8912896
 s_mov_b32 s36, 1
 s_mov_b32 s37, 0
 s_waitcnt lgkmcnt(0)
 buffer_load_dword v11, v7, s[12:15], s34 offen offset:0 sc1
L_pass:
 s_mov_b32 s30, 2097152
 s_mov_b32 s35, s36
 v_mov_b32 v224, 0xff800000
 v_mov_b32 v225, 0xff800000
 v_mov_b32 v226, 0xff800000
 v_mov_b32 v227, 0xff800000
L_mx:
 buffer_load_dwordx4 v[232:235], v10, s[12:15], s30 offen offset:0 sc1
 buffer_load_dwordx4 v[236:239], v10, s[12:15], s30 offen offset:1024 sc1
 s_add_u32 s30, s30, 4096
 s_sub_u32 s35, s35, 1
 s_cmp_lg_u32 s35, 0
 s_cbranch_scc1 L_nopre
 s_mov_b32 s30, s31
 buffer_load_dwordx4 v[160:163], v10, s[12:15], s30 offen offset:0 sc1
 buffer_load_dwordx4 v[164:167], v10, s[12:15], s30 offen offset:1024 sc1
 buffer_load_dwordx4 v[168:171], v10, s[12:15], s30 offen offset:2048 sc1
 buffer_load_dwordx4 v[172:175], v10, s[12:15], s30 offen offset:3072 sc1
 s_add_u32 s30, s30, 4096
 buffer_load_dwordx4 v[176:179], v10, s[12:15], s30 offen offset:0 sc1
 buffer_load_dwordx4 v[180:183], v10, s[12:15], s30 offen offset:1024 sc1
 buffer_load_dwordx4 v[184:187], v10, s[12:15], s30 offen offset:2048 sc1
 buffer_load_dwordx4 v[188:191], v10, s[12:15], s30 offen offset:3072 sc1
 s_add_u32 s30, s30, 4096
 buffer_load_dwordx4 v[192:195], v10, s[12:15], s30 offen offset:0 sc1
 buffer_load_dwordx4 v[196:199], v10, s[12:15], s30 offen offset:1024 sc1
 buffer_load_dwordx4 v[200:203], v10, s[12:15], s30 offen offset:2048 sc1
 buffer_load_dwordx4 v[204:207], v10, s[12:15], s30 offen offset:3072 sc1
 s_add_u32 s30, s30, 4096
 s_waitcnt vmcnt(12)
 s_branch L_mx2
L_nopre:
 s_waitcnt vmcnt(0)
L_mx2:
 s_waitcnt lgkmcnt(0)
 s_mov_b64 exec, 1
 v_mov_b32 v8, 162876
 v_mov_b32 v9, 1
 ds_add_u32 v8, v9
 s_mov_b64 exec, -1
 v_mfma_f32_32x32x16_bf16 v[48:63], v[232:235], v[16:19], 0
 v_mfma_f32_32x32x16_bf16 v[48:63], v[236:239], v[20:23], v[48:63]
 v_mfma_f32_32x32x16_bf16 v[64:79], v[232:235], v[24:27], 0
 v_mfma_f32_32x32x16_bf16 v[64:79], v[236:239], v[28:31], v[64:79]
 v_mfma_f32_32x32x16_bf16 v[80:95], v[232:235], v[32:35], 0
 v_mfma_f32_32x32x16_bf16 v[80:95], v[236:239], v[36:39], v[80:95]
 v_mfma_f32_32x32x16_bf16 v[96:111], v[232:235], v[40:43], 0
 v_mfma_f32_32x32x16_bf16 v[96:111], v[236:239], v[44:47], v[96:111]
 s_nop 5
 v_max3_f32 v224, v48, v49, v224
 v_max3_f32 v224, v50, v51, v224
 v_max3_f32 v224, v52, v53, v224
 v_max3_f32 v224, v54, v55, v224
 v_max3_f32 v224, v56, v57, v224
 v_max3_f32 v224, v58, v59, v224
 v_max3_f32 v224, v60, v61, v224
 v_max3_f32 v224, v62, v63, v224
 v_max3_f32 v225, v64, v65, v225
 v_max3_f32 v225, v66, v67, v225
 v_max3_f32 v225, v68, v69, v225
 v_max3_f32 v225, v70, v71, v225
 v_max3_f32 v225, v72, v73, v225
 v_max3_f32 v225, v74, v75, v225
 v_max3_f32 v225, v76, v77, v225
 v_max3_f32 v225, v78, v79, v225
 v_max3_f32 v226, v80, v81, v226
 v_max3_f32 v226, v82, v83, v226
 v_max3_f32 v226, v84, v85, v226
 v_max3_f32 v226, v86, v87, v226
 v_max3_f32 v226, v88, v89, v226
 v_max3_f32 v226, v90, v91, v226
 v_max3_f32 v226, v92, v93, v226
 v_max3_f32 v226, v94, v95, v226
 v_max3_f32 v227, v96, v97, v227
 v_max3_f32 v227, v98, v99, v227
 v_max3_f32 v227, v100, v101, v227
 v_max3_f32 v227, v102, v103, v227
 v_max3_f32 v227, v104, v105, v227
 v_max3_f32 v227, v106, v107, v227
 v_max3_f32 v227, v108, v109, v227
 v_max3_f32 v227, v110, v111, v227
 s_cmp_lg_u32 s35, 0
 s_cbranch_scc1 L_mx
 v_cmp_gt_u32 vcc, 32, v1
 v_mov_b32 v228, v224
 v_mov_b32 v229, v225
 v_mov_b32 v230, v226
 v_mov_b32 v231, v227
 v_permlane32_swap_b32 v224, v228
 v_permlane32_swap_b32 v225, v229
 v_permlane32_swap_b32 v226, v230
 v_permlane32_swap_b32 v227, v231
 v_max_f32 v224, v224, v228
 v_xor_b32 v224, 0x80000000, v224
 v_and_b32 v228, 0xffff0000, v224
 v_sub_f32 v224, v224, v228
 v_lshrrev_b32 v228, 16, v228
 v_and_b32 v8, 0xffff0000, v224
 v_sub_f32 v224, v224, v8
 v_or_b32 v228, v228, v8
 v_lshrrev_b32 v224, 16, v224
 v_cndmask_b32 v22, v228, v22, vcc
 v_cndmask_b32 v23, v224, v23, vcc
 v_max_f32 v225, v225, v229
 v_xor_b32 v225, 0x80000000, v225
 v_and_b32 v229, 0xffff0000, v225
 v_sub_f32 v225, v225, v229
 v_lshrrev_b32 v229, 16, v229
 v_and_b32 v8, 0xffff0000, v225
 v_sub_f32 v225, v225, v8
 v_or_b32 v229, v229, v8
 v_lshrrev_b32 v225, 16, v225
 v_cndmask_b32 v30, v229, v30, vcc
 v_cndmask_b32 v31, v225, v31, vcc
 v_max_f32 v226, v226, v230
 v_xor_b32 v226, 0x80000000, v226
 v_and_b32 v230, 0xffff0000, v226
 v_sub_f32 v226, v226, v230
 v_lshrrev_b32 v230, 16, v230
 v_and_b32 v8, 0xffff0000, v226
 v_sub_f32 v226, v226, v8
 v_or_b32 v230, v230, v8
 v_lshrrev_b32 v226, 16, v226
 v_cndmask_b32 v38, v230, v38, vcc
 v_cndmask_b32 v39, v226, v39, vcc
 v_max_f32 v227, v227, v231
 v_xor_b32 v227, 0x80000000, v227
 v_and_b32 v231, 0xffff0000, v227
 v_sub_f32 v227, v227, v231
 v_lshrrev_b32 v231, 16, v231
 v_and_b32 v8, 0xffff0000, v227
 v_sub_f32 v227, v227, v8
 v_or_b32 v231, v231, v8
 v_lshrrev_b32 v227, 16, v227
 v_cndmask_b32 v46, v231, v46, vcc
 v_cndmask_b32 v47, v227, v47, vcc
 v_mov_b32 v48, 0
 v_mov_b32 v49, 0
 v_mov_b32 v50, 0
 v_mov_b32 v51, 0
 v_mov_b32 v52, 0
 v_mov_b32 v53, 0
 v_mov_b32 v54, 0
 v_mov_b32 v55, 0
 v_mov_b32 v56, 0
 v_mov_b32 v57, 0
 v_mov_b32 v58, 0
 v_mov_b32 v59, 0
 v_mov_b32 v60, 0
 v_mov_b32 v61, 0
 v_mov_b32 v62, 0
 v_mov_b32 v63, 0
 v_mov_b32 v64, 0
 v_mov_b32 v65, 0
 v_mov_b32 v66, 0
 v_mov_b32 v67, 0
 v_mov_b32 v68, 0
 v_mov_b32 v69, 0
 v_mov_b32 v70, 0
 v_mov_b32 v71, 0
 v_mov_b32 v72, 0
 v_mov_b32 v73, 0
 v_mov_b32 v74, 0
 v_mov_b32 v75, 0
 v_mov_b32 v76, 0
 v_mov_b32 v77, 0
 v_mov_b32 v78, 0
 v_mov_b32 v79, 0
 v_mov_b32 v80, 0
 v_mov_b32 v81, 0
 v_mov_b32 v82, 0
 v_mov_b32 v83, 0
 v_mov_b32 v84, 0
 v_mov_b32 v85, 0
 v_mov_b32 v86, 0
 v_mov_b32 v87, 0
 v_mov_b32 v88, 0
 v_mov_b32 v89, 0
 v_mov_b32 v90, 0
 v_mov_b32 v91, 0
 v_mov_b32 v92, 0
 v_mov_b32 v93, 0
 v_mov_b32 v94, 0
 v_mov_b32 v95, 0
 v_mov_b32 v96, 0
 v_mov_b32 v97, 0
 v_mov_b32 v98, 0
 v_mov_b32 v99, 0
 v_mov_b32 v100, 0
 v_mov_b32 v101, 0
 v_mov_b32 v102, 0
 v_mov_b32 v103, 0
 v_mov_b32 v104, 0
 v_mov_b32 v105, 0
 v_mov_b32 v106, 0
 v_mov_b32 v107, 0
 v_mov_b32 v108, 0
 v_mov_b32 v109, 0
 v_mov_b32 v110, 0
 v_mov_b32 v111, 0
 v_mov_b32 v156, 0
 v_mov_b32 v220, 0
 v_mov_b32 v157, 0
 v_mov_b32 v221, 0
 v_mov_b32 v158, 0
 v_mov_b32 v222, 0
 v_mov_b32 v159, 0
 v_mov_b32 v223, 0
 s_waitcnt vmcnt(8)
 s_mov_b32 s35, 4
 v_mfma_f32_32x32x16_bf16 v[112:127], v[160:163], v[16:19], 0
 v_mfma_f32_32x32x16_bf16 v[112:127], v[164:167], v[20:23], v[112:127]
 s_nop 11
L_loop:
 v_mfma_f32_32x32x16_bf16 v[128:143], v[160:163], v[24:27], 0
 v_exp_f32 v112, v112
 v_exp_f32 v113, v113
 v_exp_f32 v114, v114
 v_exp_f32 v115, v115
 v_exp_f32 v116, v116
 v_cvt_pk_bf16_f32 v144, v112, v113
 v_cvt_pk_bf16_f32 v145, v114, v115
 v_mfma_f32_32x32x16_bf16 v[96:111], v[220:223], v[156:159], v[96:111]
 s_setprio 3
 buffer_load_dwordx4 v[208:211], v10, s[12:15], s30 offen offset:0 sc1
 buffer_load_dwordx4 v[212:215], v10, s[12:15], s30 offen offset:1024 sc1
 buffer_load_dwordx4 v[216:219], v10, s[12:15], s30 offen offset:2048 sc1
 buffer_load_dwordx4 v[220:223], v10, s[12:15], s30 offen offset:3072 sc1
 s_setprio 0
 s_add_u32 s30, s30, 4096
 v_exp_f32 v117, v117
 v_exp_f32 v118, v118
 v_exp_f32 v119, v119
 v_exp_f32 v120, v120
 v_cvt_pk_bf16_f32 v146, v116, v117
 v_cvt_pk_bf16_f32 v147, v118, v119
 v_mfma_f32_32x32x16_bf16 v[128:143], v[164:167], v[28:31], v[128:143]
 v_exp_f32 v121, v121
 v_exp_f32 v122, v122
 v_exp_f32 v123, v123
 v_exp_f32 v124, v124
 v_cvt_pk_bf16_f32 v148, v120, v121
 v_cvt_pk_bf16_f32 v149, v122, v123
 v_mfma_f32_32x32x16_bf16 v[48:63], v[168:171], v[144:147], v[48:63]
 v_exp_f32 v125, v125
 v_exp_f32 v126, v126
 v_exp_f32 v127, v127
 v_cvt_pk_bf16_f32 v150, v124, v125
 v_cvt_pk_bf16_f32 v151, v126, v127
 v_mfma_f32_32x32x16_bf16 v[112:127], v[160:163], v[32:35], 0
 v_exp_f32 v128, v128
 v_exp_f32 v129, v129
 v_exp_f32 v130, v130
 v_exp_f32 v131, v131
 v_exp_f32 v132, v132
 v_cvt_pk_bf16_f32 v152, v128, v129
 v_cvt_pk_bf16_f32 v153, v130, v131
 v_mfma_f32_32x32x16_bf16 v[48:63], v[172:175], v[148:151], v[48:63]
 v_exp_f32 v133, v133
 v_exp_f32 v134, v134
 v_exp_f32 v135, v135
 v_exp_f32 v136, v136
 v_cvt_pk_bf16_f32 v154, v132, v133
 v_cvt_pk_bf16_f32 v155, v134, v135
 v_mfma_f32_32x32x16_bf16 v[112:127], v[164:167], v[36:39], v[112:127]
 v_exp_f32 v137, v137
 v_exp_f32 v138, v138
 v_exp_f32 v139, v139
 v_exp_f32 v140, v140
 v_cvt_pk_bf16_f32 v156, v136, v137
 v_cvt_pk_bf16_f32 v157, v138, v139
 v_mfma_f32_32x32x16_bf16 v[64:79], v[168:171], v[152:155], v[64:79]
 v_exp_f32 v141, v141
 v_exp_f32 v142, v142
 v_exp_f32 v143, v143
 v_cvt_pk_bf16_f32 v158, v140, v141
 v_cvt_pk_bf16_f32 v159, v142, v143
 v_mfma_f32_32x32x16_bf16 v[128:143], v[160:163], v[40:43], 0
 v_exp_f32 v112, v112
 v_exp_f32 v113, v113
 v_exp_f32 v114, v114
 v_exp_f32 v115, v115
 v_exp_f32 v116, v116
 v_cvt_pk_bf16_f32 v144, v112, v113
 v_cvt_pk_bf16_f32 v145, v114, v115
 v_mfma_f32_32x32x16_bf16 v[64:79], v[172:175], v[156:159], v[64:79]
 v_exp_f32 v117, v117
 v_exp_f32 v118, v118
 v_exp_f32 v119, v119
 v_exp_f32 v120, v120
 v_cvt_pk_bf16_f32 v146, v116, v117
 v_cvt_pk_bf16_f32 v147, v118, v119
 v_mfma_f32_32x32x16_bf16 v[128:143], v[164:167], v[44:47], v[128:143]
 v_exp_f32 v121, v121
 v_exp_f32 v122, v122
 v_exp_f32 v123, v123
 v_exp_f32 v124, v124
 v_cvt_pk_bf16_f32 v148, v120, v121
 v_cvt_pk_bf16_f32 v149, v122, v123
 v_mfma_f32_32x32x16_bf16 v[80:95], v[168:171], v[144:147], v[80:95]
 v_exp_f32 v125, v125
 v_exp_f32 v126, v126
 v_exp_f32 v127, v127
 v_cvt_pk_bf16_f32 v150, v124, v125
 v_cvt_pk_bf16_f32 v151, v126, v127
 s_waitcnt vmcnt(8)
 v_mfma_f32_32x32x16_bf16 v[112:127], v[176:179], v[16:19], 0
 v_exp_f32 v128, v128
 v_exp_f32 v129, v129
 v_exp_f32 v130, v130
 v_exp_f32 v131, v131
 v_exp_f32 v132, v132
 v_cvt_pk_bf16_f32 v152, v128, v129
 v_cvt_pk_bf16_f32 v153, v130, v131
 v_mfma_f32_32x32x16_bf16 v[80:95], v[172:175], v[148:151], v[80:95]
 v_exp_f32 v133, v133
 v_exp_f32 v134, v134
 v_exp_f32 v135, v135
 v_exp_f32 v136, v136
 v_cvt_pk_bf16_f32 v154, v132, v133
 v_cvt_pk_bf16_f32 v155, v134, v135
 v_mfma_f32_32x32x16_bf16 v[112:127], v[180:183], v[20:23], v[112:127]
 v_exp_f32 v137, v137
 v_exp_f32 v138, v138
 v_exp_f32 v139, v139
 v_exp_f32 v140, v140
 v_cvt_pk_bf16_f32 v156, v136, v137
 v_cvt_pk_bf16_f32 v157, v138, v139
 v_mfma_f32_32x32x16_bf16 v[96:111], v[168:171], v[152:155], v[96:111]
 v_exp_f32 v141, v141
 v_exp_f32 v142, v142
 v_exp_f32 v143, v143
 v_cvt_pk_bf16_f32 v158, v140, v141
 v_cvt_pk_bf16_f32 v159, v142, v143
 v_mfma_f32_32x32x16_bf16 v[128:143], v[176:179], v[24:27], 0
 v_exp_f32 v112, v112
 v_exp_f32 v113, v113
 v_exp_f32 v114, v114
 v_exp_f32 v115, v115
 v_exp_f32 v116, v116
 v_cvt_pk_bf16_f32 v144, v112, v113
 v_cvt_pk_bf16_f32 v145, v114, v115
 v_mfma_f32_32x32x16_bf16 v[96:111], v[172:175], v[156:159], v[96:111]
 s_setprio 3
 buffer_load_dwordx4 v[160:163], v10, s[12:15], s30 offen offset:0 sc1
 buffer_load_dwordx4 v[164:167], v10, s[12:15], s30 offen offset:1024 sc1
 buffer_load_dwordx4 v[168:171], v10, s[12:15], s30 offen offset:2048 sc1
 buffer_load_dwordx4 v[172:175], v10, s[12:15], s30 offen offset:3072 sc1
 s_setprio 0
 s_add_u32 s30, s30, 4096
 v_exp_f32 v117, v117
 v_exp_f32 v118, v118
 v_exp_f32 v119, v119
 v_exp_f32 v120, v120
 v_cvt_pk_bf16_f32 v146, v116, v117
 v_cvt_pk_bf16_f32 v147, v118, v119
 v_mfma_f32_32x32x16_bf16 v[128:143], v[180:183], v[28:31], v[128:143]
 v_exp_f32 v121, v121
 v_exp_f32 v122, v122
 v_exp_f32 v123, v123
 v_exp_f32 v124, v124
 v_cvt_pk_bf16_f32 v148, v120, v121
 v_cvt_pk_bf16_f32 v149, v122, v123
 v_mfma_f32_32x32x16_bf16 v[48:63], v[184:187], v[144:147], v[48:63]
 v_exp_f32 v125, v125
 v_exp_f32 v126, v126
 v_exp_f32 v127, v127
 v_cvt_pk_bf16_f32 v150, v124, v125
 v_cvt_pk_bf16_f32 v151, v126, v127
 v_mfma_f32_32x32x16_bf16 v[112:127], v[176:179], v[32:35], 0
 v_exp_f32 v128, v128
 v_exp_f32 v129, v129
 v_exp_f32 v130, v130
 v_exp_f32 v131, v131
 v_exp_f32 v132, v132
 v_cvt_pk_bf16_f32 v152, v128, v129
 v_cvt_pk_bf16_f32 v153, v130, v131
 v_mfma_f32_32x32x16_bf16 v[48:63], v[188:191], v[148:151], v[48:63]
 v_exp_f32 v133, v133
 v_exp_f32 v134, v134
 v_exp_f32 v135, v135
 v_exp_f32 v136, v136
 v_cvt_pk_bf16_f32 v154, v132, v133
 v_cvt_pk_bf16_f32 v155, v134, v135
 v_mfma_f32_32x32x16_bf16 v[112:127], v[180:183], v[36:39], v[112:127]
 v_exp_f32 v137, v137
 v_exp_f32 v138, v138
 v_exp_f32 v139, v139
 v_exp_f32 v140, v140
 v_cvt_pk_bf16_f32 v156, v136, v137
 v_cvt_pk_bf16_f32 v157, v138, v139
 v_mfma_f32_32x32x16_bf16 v[64:79], v[184:187], v[152:155], v[64:79]
 v_exp_f32 v141, v141
 v_exp_f32 v142, v142
 v_exp_f32 v143, v143
 v_cvt_pk_bf16_f32 v158, v140, v141
 v_cvt_pk_bf16_f32 v159, v142, v143
 v_mfma_f32_32x32x16_bf16 v[128:143], v[176:179], v[40:43], 0
 v_exp_f32 v112, v112
 v_exp_f32 v113, v113
 v_exp_f32 v114, v114
 v_exp_f32 v115, v115
 v_exp_f32 v116, v116
 v_cvt_pk_bf16_f32 v144, v112, v113
 v_cvt_pk_bf16_f32 v145, v114, v115
 v_mfma_f32_32x32x16_bf16 v[64:79], v[188:191], v[156:159], v[64:79]
 v_exp_f32 v117, v117
 v_exp_f32 v118, v118
 v_exp_f32 v119, v119
 v_exp_f32 v120, v120
 v_cvt_pk_bf16_f32 v146, v116, v117
 v_cvt_pk_bf16_f32 v147, v118, v119
 v_mfma_f32_32x32x16_bf16 v[128:143], v[180:183], v[44:47], v[128:143]
 v_exp_f32 v121, v121
 v_exp_f32 v122, v122
 v_exp_f32 v123, v123
 v_exp_f32 v124, v124
 v_cvt_pk_bf16_f32 v148, v120, v121
 v_cvt_pk_bf16_f32 v149, v122, v123
 v_mfma_f32_32x32x16_bf16 v[80:95], v[184:187], v[144:147], v[80:95]
 v_exp_f32 v125, v125
 v_exp_f32 v126, v126
 v_exp_f32 v127, v127
 v_cvt_pk_bf16_f32 v150, v124, v125
 v_cvt_pk_bf16_f32 v151, v126, v127
 s_waitcnt vmcnt(8)
 v_mfma_f32_32x32x16_bf16 v[112:127], v[192:195], v[16:19], 0
 v_exp_f32 v128, v128
 v_exp_f32 v129, v129
 v_exp_f32 v130, v130
 v_exp_f32 v131, v131
 v_exp_f32 v132, v132
 v_cvt_pk_bf16_f32 v152, v128, v129
 v_cvt_pk_bf16_f32 v153, v130, v131
 v_mfma_f32_32x32x16_bf16 v[80:95], v[188:191], v[148:151], v[80:95]
 v_exp_f32 v133, v133
 v_exp_f32 v134, v134
 v_exp_f32 v135, v135
 v_exp_f32 v136, v136
 v_cvt_pk_bf16_f32 v154, v132, v133
 v_cvt_pk_bf16_f32 v155, v134, v135
 v_mfma_f32_32x32x16_bf16 v[112:127], v[196:199], v[20:23], v[112:127]
 v_exp_f32 v137, v137
 v_exp_f32 v138, v138
 v_exp_f32 v139, v139
 v_exp_f32 v140, v140
 v_cvt_pk_bf16_f32 v156, v136, v137
 v_cvt_pk_bf16_f32 v157, v138, v139
 v_mfma_f32_32x32x16_bf16 v[96:111], v[184:187], v[152:155], v[96:111]
 v_exp_f32 v141, v141
 v_exp_f32 v142, v142
 v_exp_f32 v143, v143
 v_cvt_pk_bf16_f32 v158, v140, v141
 v_cvt_pk_bf16_f32 v159, v142, v143
 v_mfma_f32_32x32x16_bf16 v[128:143], v[192:195], v[24:27], 0
 v_exp_f32 v112, v112
 v_exp_f32 v113, v113
 v_exp_f32 v114, v114
 v_exp_f32 v115, v115
 v_exp_f32 v116, v116
 v_cvt_pk_bf16_f32 v144, v112, v113
 v_cvt_pk_bf16_f32 v145, v114, v115
 v_mfma_f32_32x32x16_bf16 v[96:111], v[188:191], v[156:159], v[96:111]
 s_setprio 3
 buffer_load_dwordx4 v[176:179], v10, s[12:15], s30 offen offset:0 sc1
 buffer_load_dwordx4 v[180:183], v10, s[12:15], s30 offen offset:1024 sc1
 buffer_load_dwordx4 v[184:187], v10, s[12:15], s30 offen offset:2048 sc1
 buffer_load_dwordx4 v[188:191], v10, s[12:15], s30 offen offset:3072 sc1
 s_setprio 0
 s_add_u32 s30, s30, 4096
 v_exp_f32 v117, v117
 v_exp_f32 v118, v118
 v_exp_f32 v119, v119
 v_exp_f32 v120, v120
 v_cvt_pk_bf16_f32 v146, v116, v117
 v_cvt_pk_bf16_f32 v147, v118, v119
 v_mfma_f32_32x32x16_bf16 v[128:143], v[196:199], v[28:31], v[128:143]
 v_exp_f32 v121, v121
 v_exp_f32 v122, v122
 v_exp_f32 v123, v123
 v_exp_f32 v124, v124
 v_cvt_pk_bf16_f32 v148, v120, v121
 v_cvt_pk_bf16_f32 v149, v122, v123
 v_mfma_f32_32x32x16_bf16 v[48:63], v[200:203], v[144:147], v[48:63]
 v_exp_f32 v125, v125
 v_exp_f32 v126, v126
 v_exp_f32 v127, v127
 v_cvt_pk_bf16_f32 v150, v124, v125
 v_cvt_pk_bf16_f32 v151, v126, v127
 v_mfma_f32_32x32x16_bf16 v[112:127], v[192:195], v[32:35], 0
 v_exp_f32 v128, v128
 v_exp_f32 v129, v129
 v_exp_f32 v130, v130
 v_exp_f32 v131, v131
 v_exp_f32 v132, v132
 v_cvt_pk_bf16_f32 v152, v128, v129
 v_cvt_pk_bf16_f32 v153, v130, v131
 v_mfma_f32_32x32x16_bf16 v[48:63], v[204:207], v[148:151], v[48:63]
 v_exp_f32 v133, v133
 v_exp_f32 v134, v134
 v_exp_f32 v135, v135
 v_exp_f32 v136, v136
 v_cvt_pk_bf16_f32 v154, v132, v133
 v_cvt_pk_bf16_f32 v155, v134, v135
 v_mfma_f32_32x32x16_bf16 v[112:127], v[196:199], v[36:39], v[112:127]
 v_exp_f32 v137, v137
 v_exp_f32 v138, v138
 v_exp_f32 v139, v139
 v_exp_f32 v140, v140
 v_cvt_pk_bf16_f32 v156, v136, v137
 v_cvt_pk_bf16_f32 v157, v138, v139
 v_mfma_f32_32x32x16_bf16 v[64:79], v[200:203], v[152:155], v[64:79]
 v_exp_f32 v141, v141
 v_exp_f32 v142, v142
 v_exp_f32 v143, v143
 v_cvt_pk_bf16_f32 v158, v140, v141
 v_cvt_pk_bf16_f32 v159, v142, v143
 v_mfma_f32_32x32x16_bf16 v[128:143], v[192:195], v[40:43], 0
 v_exp_f32 v112, v112
 v_exp_f32 v113, v113
 v_exp_f32 v114, v114
 v_exp_f32 v115, v115
 v_exp_f32 v116, v116
 v_cvt_pk_bf16_f32 v144, v112, v113
 v_cvt_pk_bf16_f32 v145, v114, v115
 v_mfma_f32_32x32x16_bf16 v[64:79], v[204:207], v[156:159], v[64:79]
 v_exp_f32 v117, v117
 v_exp_f32 v118, v118
 v_exp_f32 v119, v119
 v_exp_f32 v120, v120
 v_cvt_pk_bf16_f32 v146, v116, v117
 v_cvt_pk_bf16_f32 v147, v118, v119
 v_mfma_f32_32x32x16_bf16 v[128:143], v[196:199], v[44:47], v[128:143]
 v_exp_f32 v121, v121
 v_exp_f32 v122, v122
 v_exp_f32 v123, v123
 v_exp_f32 v124, v124
 v_cvt_pk_bf16_f32 v148, v120, v121
 v_cvt_pk_bf16_f32 v149, v122, v123
 v_mfma_f32_32x32x16_bf16 v[80:95], v[200:203], v[144:147], v[80:95]
 v_exp_f32 v125, v125
 v_exp_f32 v126, v126
 v_exp_f32 v127, v127
 v_cvt_pk_bf16_f32 v150, v124, v125
 v_cvt_pk_bf16_f32 v151, v126, v127
 s_waitcnt vmcnt(8)
 v_mfma_f32_32x32x16_bf16 v[112:127], v[208:211], v[16:19], 0
 v_exp_f32 v128, v128
 v_exp_f32 v129, v129
 v_exp_f32 v130, v130
 v_exp_f32 v131, v131
 v_exp_f32 v132, v132
 v_cvt_pk_bf16_f32 v152, v128, v129
 v_cvt_pk_bf16_f32 v153, v130, v131
 v_mfma_f32_32x32x16_bf16 v[80:95], v[204:207], v[148:151], v[80:95]
 v_exp_f32 v133, v133
 v_exp_f32 v134, v134
 v_exp_f32 v135, v135
 v_exp_f32 v136, v136
 v_cvt_pk_bf16_f32 v154, v132, v133
 v_cvt_pk_bf16_f32 v155, v134, v135
 v_mfma_f32_32x32x16_bf16 v[112:127], v[212:215], v[20:23], v[112:127]
 v_exp_f32 v137, v137
 v_exp_f32 v138, v138
 v_exp_f32 v139, v139
 v_exp_f32 v140, v140
 v_cvt_pk_bf16_f32 v156, v136, v137
 v_cvt_pk_bf16_f32 v157, v138, v139
 v_mfma_f32_32x32x16_bf16 v[96:111], v[200:203], v[152:155], v[96:111]
 v_exp_f32 v141, v141
 v_exp_f32 v142, v142
 v_exp_f32 v143, v143
 v_cvt_pk_bf16_f32 v158, v140, v141
 v_cvt_pk_bf16_f32 v159, v142, v143
 v_mfma_f32_32x32x16_bf16 v[128:143], v[208:211], v[24:27], 0
 v_exp_f32 v112, v112
 v_exp_f32 v113, v113
 v_exp_f32 v114, v114
 v_exp_f32 v115, v115
 v_exp_f32 v116, v116
 v_cvt_pk_bf16_f32 v144, v112, v113
 v_cvt_pk_bf16_f32 v145, v114, v115
 v_mfma_f32_32x32x16_bf16 v[96:111], v[204:207], v[156:159], v[96:111]
 s_setprio 3
 buffer_load_dwordx4 v[192:195], v10, s[12:15], s30 offen offset:0 sc1
 buffer_load_dwordx4 v[196:199], v10, s[12:15], s30 offen offset:1024 sc1
 buffer_load_dwordx4 v[200:203], v10, s[12:15], s30 offen offset:2048 sc1
 buffer_load_dwordx4 v[204:207], v10, s[12:15], s30 offen offset:3072 sc1
 s_setprio 0
 s_add_u32 s30, s30, 4096
 v_exp_f32 v117, v117
 v_exp_f32 v118, v118
 v_exp_f32 v119, v119
 v_exp_f32 v120, v120
 v_cvt_pk_bf16_f32 v146, v116, v117
 v_cvt_pk_bf16_f32 v147, v118, v119
 v_mfma_f32_32x32x16_bf16 v[128:143], v[212:215], v[28:31], v[128:143]
 v_exp_f32 v121, v121
 v_exp_f32 v122, v122
 v_exp_f32 v123, v123
 v_exp_f32 v124, v124
 v_cvt_pk_bf16_f32 v148, v120, v121
 v_cvt_pk_bf16_f32 v149, v122, v123
 v_mfma_f32_32x32x16_bf16 v[48:63], v[216:219], v[144:147], v[48:63]
 v_exp_f32 v125, v125
 v_exp_f32 v126, v126
 v_exp_f32 v127, v127
 v_cvt_pk_bf16_f32 v150, v124, v125
 v_cvt_pk_bf16_f32 v151, v126, v127
 v_mfma_f32_32x32x16_bf16 v[112:127], v[208:211], v[32:35], 0
 v_exp_f32 v128, v128
 v_exp_f32 v129, v129
 v_exp_f32 v130, v130
 v_exp_f32 v131, v131
 v_exp_f32 v132, v132
 v_cvt_pk_bf16_f32 v152, v128, v129
 v_cvt_pk_bf16_f32 v153, v130, v131
 v_mfma_f32_32x32x16_bf16 v[48:63], v[220:223], v[148:151], v[48:63]
 v_exp_f32 v133, v133
 v_exp_f32 v134, v134
 v_exp_f32 v135, v135
 v_exp_f32 v136, v136
 v_cvt_pk_bf16_f32 v154, v132, v133
 v_cvt_pk_bf16_f32 v155, v134, v135
 v_mfma_f32_32x32x16_bf16 v[112:127], v[212:215], v[36:39], v[112:127]
 v_exp_f32 v137, v137
 v_exp_f32 v138, v138
 v_exp_f32 v139, v139
 v_exp_f32 v140, v140
 v_cvt_pk_bf16_f32 v156, v136, v137
 v_cvt_pk_bf16_f32 v157, v138, v139
 v_mfma_f32_32x32x16_bf16 v[64:79], v[216:219], v[152:155], v[64:79]
 v_exp_f32 v141, v141
 v_exp_f32 v142, v142
 v_exp_f32 v143, v143
 v_cvt_pk_bf16_f32 v158, v140, v141
 v_cvt_pk_bf16_f32 v159, v142, v143
 v_mfma_f32_32x32x16_bf16 v[128:143], v[208:211], v[40:43], 0
 v_exp_f32 v112, v112
 v_exp_f32 v113, v113
 v_exp_f32 v114, v114
 v_exp_f32 v115, v115
 v_exp_f32 v116, v116
 v_cvt_pk_bf16_f32 v144, v112, v113
 v_cvt_pk_bf16_f32 v145, v114, v115
 v_mfma_f32_32x32x16_bf16 v[64:79], v[220:223], v[156:159], v[64:79]
 v_exp_f32 v117, v117
 v_exp_f32 v118, v118
 v_exp_f32 v119, v119
 v_exp_f32 v120, v120
 v_cvt_pk_bf16_f32 v146, v116, v117
 v_cvt_pk_bf16_f32 v147, v118, v119
 v_mfma_f32_32x32x16_bf16 v[128:143], v[212:215], v[44:47], v[128:143]
 v_exp_f32 v121, v121
 v_exp_f32 v122, v122
 v_exp_f32 v123, v123
 v_exp_f32 v124, v124
 v_cvt_pk_bf16_f32 v148, v120, v121
 v_cvt_pk_bf16_f32 v149, v122, v123
 v_mfma_f32_32x32x16_bf16 v[80:95], v[216:219], v[144:147], v[80:95]
 v_exp_f32 v125, v125
 v_exp_f32 v126, v126
 v_exp_f32 v127, v127
 v_cvt_pk_bf16_f32 v150, v124, v125
 v_cvt_pk_bf16_f32 v151, v126, v127
 s_waitcnt vmcnt(8)
 v_mfma_f32_32x32x16_bf16 v[112:127], v[160:163], v[16:19], 0
 v_exp_f32 v128, v128
 v_exp_f32 v129, v129
 v_exp_f32 v130, v130
 v_exp_f32 v131, v131
 v_exp_f32 v132, v132
 v_cvt_pk_bf16_f32 v152, v128, v129
 v_cvt_pk_bf16_f32 v153, v130, v131
 v_mfma_f32_32x32x16_bf16 v[80:95], v[220:223], v[148:151], v[80:95]
 v_exp_f32 v133, v133
 v_exp_f32 v134, v134
 v_exp_f32 v135, v135
 v_exp_f32 v136, v136
 v_cvt_pk_bf16_f32 v154, v132, v133
 v_cvt_pk_bf16_f32 v155, v134, v135
 v_mfma_f32_32x32x16_bf16 v[112:127], v[164:167], v[20:23], v[112:127]
 v_exp_f32 v137, v137
 v_exp_f32 v138, v138
 v_exp_f32 v139, v139
 v_exp_f32 v140, v140
 v_cvt_pk_bf16_f32 v156, v136, v137
 v_cvt_pk_bf16_f32 v157, v138, v139
 v_mfma_f32_32x32x16_bf16 v[96:111], v[216:219], v[152:155], v[96:111]
 v_exp_f32 v141, v141
 v_exp_f32 v142, v142
 v_exp_f32 v143, v143
 v_cvt_pk_bf16_f32 v158, v140, v141
 v_cvt_pk_bf16_f32 v159, v142, v143
 s_waitcnt lgkmcnt(0)
 s_mov_b64 exec, 1
 v_mov_b32 v8, 162876
 v_mov_b32 v9, 1
 ds_add_u32 v8, v9
 s_mov_b64 exec, -1
 s_sub_u32 s35, s35, 1
 s_cmp_lg_u32 s35, 0
 s_cbranch_scc1 L_loop
 v_mfma_f32_32x32x16_bf16 v[96:111], v[220:223], v[156:159], v[96:111]
 v_mov_b32 v8, 0x5f800000
 v_cmp_nlt_f32 s[38:39], v60, v8
 v_cmp_nlt_f32 vcc, v76, v8
 s_or_b32 s39, s39, vcc_hi
 v_cmp_nlt_f32 vcc, v92, v8
 s_or_b32 s39, s39, vcc_hi
 s_nop 5
 v_cmp_nlt_f32 vcc, v108, v8
 s_or_b32 s39, s39, vcc_hi
 s_lshl_b32 s38, s5, 2
 v_mov_b32 v8, s39
 v_mov_b32 v9, s38
 v_add_u32 v9, 162816, v9
 ds_write_b32 v9, v8
 s_setprio 3
 s_mul_i32 s41, s5, 12288
 s_add_u32 s41, s41, 57344
 v_lshl_add_u32 v7, v1, 4, s41
 ds_write_b128 v7, v[64:67] offset:0
 ds_write_b128 v7, v[68:71] offset:1024
 ds_write_b128 v7, v[72:75] offset:2048
 ds_write_b128 v7, v[76:79] offset:3072
 ds_write_b128 v7, v[80:83] offset:4096
 ds_write_b128 v7, v[84:87] offset:5120
 ds_write_b128 v7, v[88:91] offset:6144
 ds_write_b128 v7, v[92:95] offset:7168
 ds_write_b128 v7, v[96:99] offset:8192
 ds_write_b128 v7, v[100:103] offset:9216
 ds_write_b128 v7, v[104:107] offset:10240
 ds_write_b128 v7, v[108:111] offset:11264
 s_waitcnt lgkmcnt(0)
 s_mov_b64 exec, 1
 v_mov_b32 v8, 162832
 v_mov_b32 v9, 1
 ds_add_u32 v8, v9
 s_mov_b64 exec, -1
 s_add_u32 s37, s37, 4
 v_mov_b32 v8, 162832
 s_mov_b32 s43, 0x400000
L_ll7:
 ds_read_b32 v9, v8
 s_waitcnt lgkmcnt(0)
 v_cmp_gt_u32 vcc, s37, v9
 s_sub_u32 s43, s43, 1
 s_cbranch_scc1 L_ld7
 s_cbranch_vccz L_ld7
 s_sleep 1
 s_branch L_ll7
L_ld7:
 v_mov_b32 v9, 162816
 ds_read_b128 v[12:15], v9
 s_xor_b32 s41, s5, 1
 s_mul_i32 s41, s41, 12288
 s_add_u32 s41, s41, 57344
 v_lshl_add_u32 v7, v1, 4, s41
 ds_read_b128 v[64:67], v7 offset:0
 ds_read_b128 v[68:71], v7 offset:1024
 ds_read_b128 v[72:75], v7 offset:2048
 ds_read_b128 v[76:79], v7 offset:3072
 s_xor_b32 s41, s5, 2
 s_mul_i32 s41, s41, 12288
 s_add_u32 s41, s41, 57344
 v_lshl_add_u32 v7, v1, 4, s41
 ds_read_b128 v[80:83], v7 offset:4096
 ds_read_b128 v[84:87], v7 offset:5120
 ds_read_b128 v[88:91], v7 offset:6144
 ds_read_b128 v[92:95], v7 offset:7168
 s_xor_b32 s41, s5, 3
 s_mul_i32 s41, s41, 12288
 s_add_u32 s41, s41, 57344
 v_lshl_add_u32 v7, v1, 4, s41
 ds_read_b128 v[96:99], v7 offset:8192
 ds_read_b128 v[100:103], v7 offset:9216
 ds_read_b128 v[104:107], v7 offset:10240
 ds_read_b128 v[108:111], v7 offset:11264
 s_waitcnt lgkmcnt(8)
 v_pk_add_f32 v[48:49], v[48:49], v[64:65]
 v_pk_add_f32 v[50:51], v[50:51], v[66:67]
 v_pk_add_f32 v[52:53], v[52:53], v[68:69]
 v_pk_add_f32 v[54:55], v[54:55], v[70:71]
 v_pk_add_f32 v[56:57], v[56:57], v[72:73]
 v_pk_add_f32 v[58:59], v[58:59], v[74:75]
 v_pk_add_f32 v[60:61], v[60:61], v[76:77]
 v_pk_add_f32 v[62:63], v[62:63], v[78:79]
 s_waitcnt lgkmcnt(4)
 v_pk_add_f32 v[48:49], v[48:49], v[80:81]
 v_pk_add_f32 v[50:51], v[50:51], v[82:83]
 v_pk_add_f32 v[52:53], v[52:53], v[84:85]
 v_pk_add_f32 v[54:55], v[54:55], v[86:87]
 v_pk_add_f32 v[56:57], v[56:57], v[88:89]
 v_pk_add_f32 v[58:59], v[58:59], v[90:91]
 v_pk_add_f32 v[60:61], v[60:61], v[92:93]
 v_pk_add_f32 v[62:63], v[62:63], v[94:95]
 s_waitcnt lgkmcnt(0)
 v_pk_add_f32 v[48:49], v[48:49], v[96:97]
 v_pk_add_f32 v[50:51], v[50:51], v[98:99]
 v_pk_add_f32 v[52:53], v[52:53], v[100:101]
 v_pk_add_f32 v[54:55], v[54:55], v[102:103]
 v_pk_add_f32 v[56:57], v[56:57], v[104:105]
 v_pk_add_f32 v[58:59], v[58:59], v[106:107]
 v_pk_add_f32 v[60:61], v[60:61], v[108:109]
 v_pk_add_f32 v[62:63], v[62:63], v[110:111]
 v_or_b32 v12, v12, v13
 v_or3_b32 v12, v12, v14, v15
 s_nop 0
 v_readfirstlane_b32 s38, v12
 s_cmp_eq_u32 s38, 0
 s_cbranch_scc1 L_fin
 s_cmp_eq_u32 s36, 1
 s_cbranch_scc0 L_fin
 s_mov_b32 s36, 64
 v_cmp_gt_u32 vcc, 32, v1
 s_nop 1
 v_cndmask_b32 v22, 0, v22, vcc
 v_cndmask_b32 v23, 0, v23, vcc
 v_cndmask_b32 v30, 0, v30, vcc
 v_cndmask_b32 v31, 0, v31, vcc
 v_cndmask_b32 v38, 0, v38, vcc
 v_cndmask_b32 v39, 0, v39, vcc
 v_cndmask_b32 v46, 0, v46, vcc
 v_cndmask_b32 v47, 0, v47, vcc
 s_waitcnt lgkmcnt(0)
 s_mov_b64 exec, 1
 v_mov_b32 v8, 162832
 v_mov_b32 v9, 1
 ds_add_u32 v8, v9
 s_mov_b64 exec, -1
 s_add_u32 s37, s37, 4
 v_mov_b32 v8, 162832
 s_mov_b32 s43, 0x400000
L_ll8:
 ds_read_b32 v9, v8
 s_waitcnt lgkmcnt(0)
 v_cmp_gt_u32 vcc, s37, v9
 s_sub_u32 s43, s43, 1
 s_cbranch_scc1 L_ld8
 s_cbranch_vccz L_ld8
 s_sleep 1
 s_branch L_ll8
L_ld8:
 s_waitcnt vmcnt(0)
 s_branch L_pass
L_fin:
 v_mov_b32 v8, v60
 v_mov_b32 v9, v60
 s_lshl_b32 s6, s4, 1
 s_lshr_b32 s7, s5, 1
 v_permlane32_swap_b32 v8, v9
 s_add_u32 s6, s6, s7
 s_mul_i32 s6, s6, 7
 v_rcp_f32 v9, v9
 s_mul_i32 s7, s3, 56
 s_and_b32 s34, s5, 1
 v_mul_f32 v9, v9, v11
 s_add_u32 s7, s7, s34
 s_lshl_b32 s7, s7, 10
 s_add_u32 s7, s7, 6815744
 v_mul_f32 v48, v48, v9
 v_mul_f32 v49, v49, v9
 v_mul_f32 v50, v50, v9
 v_mul_f32 v51, v51, v9
 v_mul_f32 v52, v52, v9
 v_mul_f32 v53, v53, v9
 v_mul_f32 v54, v54, v9
 v_mul_f32 v55, v55, v9
 v_mul_f32 v56, v56, v9
 v_mul_f32 v57, v57, v9
 v_mul_f32 v58, v58, v9
 v_mul_f32 v59, v59, v9
 v_mul_f32 v60, v60, v9
 v_mul_f32 v61, v61, v9
 v_mul_f32 v62, v62, v9
 v_mul_f32 v63, v63, v9
 v_cvt_pk_bf16_f32 v144, v48, v49
 v_cvt_pk_bf16_f32 v145, v50, v51
 v_cvt_pk_bf16_f32 v146, v52, v53
 v_cvt_pk_bf16_f32 v147, v54, v55
 v_cvt_pk_bf16_f32 v148, v56, v57
 v_cvt_pk_bf16_f32 v149, v58, v59
 v_cvt_pk_bf16_f32 v150, v60, v61
 v_cvt_pk_bf16_f32 v151, v62, v63
 v_add3_u32 v8, s6, v2, 0
 v_lshrrev_b32 v12, 2, v8
 v_lshlrev_b32 v12, 11, v12
 v_and_b32 v13, 1, v8
 v_lshl_add_u32 v12, v13, 9, v12
 v_and_b32 v13, 2, v8
 v_lshl_add_u32 v12, v13, 2, v12
 v_lshl_add_u32 v12, v3, 4, v12
 buffer_store_dwordx2 v[144:145], v12, s[12:15], s7 offen offset:0 sc1
 v_add3_u32 v8, s6, v2, 2
 v_lshrrev_b32 v12, 2, v8
 v_lshlrev_b32 v12, 11, v12
 v_and_b32 v13, 1, v8
 v_lshl_add_u32 v12, v13, 9, v12
 v_and_b32 v13, 2, v8
 v_lshl_add_u32 v12, v13, 2, v12
 v_lshl_add_u32 v12, v3, 4, v12
 buffer_store_dwordx2 v[146:147], v12, s[12:15], s7 offen offset:0 sc1
 v_add3_u32 v8, s6, v2, 4
 v_lshrrev_b32 v12, 2, v8
 v_lshlrev_b32 v12, 11, v12
 v_and_b32 v13, 1, v8
 v_lshl_add_u32 v12, v13, 9, v12
 v_and_b32 v13, 2, v8
 v_lshl_add_u32 v12, v13, 2, v12
 v_lshl_add_u32 v12, v3, 4, v12
 buffer_store_dwordx2 v[148:149], v12, s[12:15], s7 offen offset:0 sc1
 v_add3_u32 v8, s6, v2, 6
 v_lshrrev_b32 v12, 2, v8
 v_lshlrev_b32 v12, 11, v12
 v_and_b32 v13, 1, v8
 v_lshl_add_u32 v12, v13, 9, v12
 v_and_b32 v13, 2, v8
 v_lshl_add_u32 v12, v13, 2, v12
 v_lshl_add_u32 v12, v3, 4, v12
 s_mov_b32 exec_hi, 0
 buffer_store_dwordx2 v[150:151], v12, s[12:15], s7 offen offset:0 sc1
 s_lshl_b32 s6, s3, 3
 s_add_u32 s6, s6, s4
 s_lshl_b32 s6, s6, 2
 s_add_u32 s6, s6, s5
 s_lshl_b32 s6, s6, 7
 s_add_u32 s6, s6, 9568256
 s_waitcnt vmcnt(0)
 s_mov_b64 exec, 1
 v_mov_b32 v8, 0
 v_mov_b32 v9, s60
 buffer_store_dword v9, v8, s[12:15], s6 offen offset:0 sc1
 s_mov_b64 exec, -1
 s_endpgm
L_g:
 s_setprio 3
 s_load_dwordx2 s[24:25], s[0:1], 0
 s_load_dwordx2 s[28:29], s[0:1], 80
 s_load_dwordx2 s[56:57], s[0:1], 96
 s_load_dwordx2 s[32:33], s[0:1], 16
 s_load_dwordx2 s[12:13], s[0:1], 104
 s_load_dwordx2 s[8:9], s[0:1], 48
 s_load_dwordx2 s[16:17], s[0:1], 56
 s_load_dwordx2 s[20:21], s[0:1], 64
 s_mov_b32 s26, 1835008
 s_mov_b32 s27, 0x20000
 s_mov_b32 s30, 896
 s_mov_b32 s31, 0x20000
 s_mov_b32 s58, 256
 s_mov_b32 s59, 0x20000
 s_mov_b32 s34, 25088
 s_mov_b32 s35, 0x20000
 s_mov_b32 s14, 9961472
 s_mov_b32 s15, 0x20000
 s_mov_b32 s10, 7340032
 s_mov_b32 s11, 0x20000
 s_mov_b32 s18, 3584
 s_mov_b32 s19, 0x20000
 s_mov_b32 s22, 7340032
 s_mov_b32 s23, 0x20000
 s_load_dwordx2 s[62:63], s[0:1], 24
 s_sub_u32 s5, s5, 4
 s_lshr_b32 s6, s5, 1
 s_and_b32 s7, s5, 1
 s_mul_i32 s40, s5, 10240
 s_add_u32 s40, s40, 121856
 s_mul_i32 s48, s5, 14336
 s_and_b32 s44, s2, 7
 s_lshr_b32 s45, s2, 3
 s_and_b32 s47, s44, 1
 s_add_u32 s36, s45, s47
 s_cmp_lt_u32 s36, 25
 s_cselect_b32 s46, 4, 0
 s_lshr_b32 s50, s44, 1
 s_mul_i32 s50, s50, 49
 s_mul_i32 s47, s47, 25
 s_add_u32 s50, s50, s47
 s_add_u32 s51, s45, s50
 s_mul_i32 s50, s51, 9363
 s_lshr_b32 s50, s50, 16
 s_mul_i32 s47, s50, 7
 s_sub_u32 s51, s51, s47
 s_and_b32 s47, s50, 3
 s_lshl_b32 s49, s5, 2
 s_add_u32 s49, s49, s47
 s_sub_u32 s47, 4, s47
 s_mul_i32 s38, s49, 458752
 s_lshl_b32 s52, s50, 7
 s_add_u32 s38, s38, s52
 s_lshl_b32 s39, s51, 4
 s_add_u32 s39, s39, s49
 s_lshl_b32 s39, s39, 14
 s_add_u32 s39, s39, 2621440
 s_lshl_b32 s37, s6, 6
 s_add_u32 s52, s52, s37
 s_lshl_b32 s53, s51, 2
 s_add_u32 s53, s53, s5
 s_lshl_b32 s53, s53, 12
 s_add_u32 s53, s53, 9699328
 v_mov_b32 v8, 0
 s_waitcnt lgkmcnt(0)
 buffer_load_dword v255, v8, s[56:59], 0 offen offset:0 sc1
 s_cmp_eq_u32 s4, 7
 s_cbranch_scc1 L_kv
 s_cmp_ge_u32 s4, 4
 s_cbranch_scc0 L_ln
 s_cmp_eq_u32 s6, 1
 s_cselect_b32 s32, s62, s32
 s_cselect_b32 s33, s63, s33
 s_sub_u32 s36, s45, 16
 s_lshl_b32 s36, s36, 1
 s_add_u32 s36, s36, s7
 s_mul_i32 s36, s36, 9
 v_min_u32 v7, 8, v1
 v_add_u32 v7, s36, v7
 v_min_u32 v7, 195, v7
 v_lshlrev_b32 v7, 7, v7
 buffer_load_dword v252, v7, s[32:35], 0 offen offset:0
 s_waitcnt vmcnt(0)
 s_mov_b32 s43, 0x40000
 v_mov_b32 v8, 0
L_nl9:
 v_readfirstlane_b32 s60, v255
 s_cmp_lg_u32 s60, 0
 s_cbranch_scc1 L_nd9
 s_sub_u32 s43, s43, 1
 s_cbranch_scc1 L_nd9
 buffer_load_dword v255, v8, s[56:59], 0 offen offset:0 sc1
 s_waitcnt vmcnt(0)
 s_branch L_nl9
L_nd9:
 s_branch L_w1p
L_ln:
 s_lshl_b32 s36, s3, 2
 s_add_u32 s36, s36, s4
 s_lshl_b32 s37, s36, 2
 s_add_u32 s37, s37, s5
 v_lshl_add_u32 v50, s37, 2, v2
 v_lshlrev_b32 v7, 4, v3
 v_mov_b32 v9, 0x7ff00000
 v_cmp_gt_u32 vcc, 28, v3
 v_mul_u32_u24 v8, 896, v50
 s_nop 0
 v_cndmask_b32 v7, v9, v7, vcc
 v_add_u32 v8, v8, v7
 buffer_load_dwordx4 v[52:55], v8, s[24:27], 0 offen offset:0
 buffer_load_dwordx4 v[56:59], v8, s[24:27], 0 offen offset:448
 buffer_load_dwordx4 v[60:63], v8, s[24:27], 0 offen offset:1792
 buffer_load_dwordx4 v[64:67], v8, s[24:27], 0 offen offset:2240
 buffer_load_dwordx4 v[68:71], v7, s[28:31], 0 offen offset:0
 buffer_load_dwordx4 v[72:75], v7, s[28:31], 0 offen offset:448
 s_waitcnt vmcnt(0)
 v_lshlrev_b32 v80, 16, v52
 v_and_b32 v81, 0xffff0000, v52
 v_lshlrev_b32 v82, 16, v53
 v_and_b32 v83, 0xffff0000, v53
 v_lshlrev_b32 v84, 16, v54
 v_and_b32 v85, 0xffff0000, v54
 v_lshlrev_b32 v86, 16, v55
 v_and_b32 v87, 0xffff0000, v55
 v_lshlrev_b32 v88, 16, v56
 v_and_b32 v89, 0xffff0000, v56
 v_lshlrev_b32 v90, 16, v57
 v_and_b32 v91, 0xffff0000, v57
 v_lshlrev_b32 v92, 16, v58
 v_and_b32 v93, 0xffff0000, v58
 v_lshlrev_b32 v94, 16, v59
 v_and_b32 v95, 0xffff0000, v59
 v_lshlrev_b32 v96, 16, v60
 v_and_b32 v97, 0xffff0000, v60
 v_lshlrev_b32 v98, 16, v61
 v_and_b32 v99, 0xffff0000, v61
 v_lshlrev_b32 v100, 16, v62
 v_and_b32 v101, 0xffff0000, v62
 v_lshlrev_b32 v102, 16, v63
 v_and_b32 v103, 0xffff0000, v63
 v_lshlrev_b32 v104, 16, v64
 v_and_b32 v105, 0xffff0000, v64
 v_lshlrev_b32 v106, 16, v65
 v_and_b32 v107, 0xffff0000, v65
 v_lshlrev_b32 v108, 16, v66
 v_and_b32 v109, 0xffff0000, v66
 v_lshlrev_b32 v110, 16, v67
 v_and_b32 v111, 0xffff0000, v67
 v_lshlrev_b32 v112, 16, v68
 v_and_b32 v113, 0xffff0000, v68
 v_lshlrev_b32 v114, 16, v69
 v_and_b32 v115, 0xffff0000, v69
 v_lshlrev_b32 v116, 16, v70
 v_and_b32 v117, 0xffff0000, v70
 v_lshlrev_b32 v118, 16, v71
 v_and_b32 v119, 0xffff0000, v71
 v_lshlrev_b32 v120, 16, v72
 v_and_b32 v121, 0xffff0000, v72
 v_lshlrev_b32 v122, 16, v73
 v_and_b32 v123, 0xffff0000, v73
 v_lshlrev_b32 v124, 16, v74
 v_and_b32 v125, 0xffff0000, v74
 v_lshlrev_b32 v126, 16, v75
 v_and_b32 v127, 0xffff0000, v75
 v_mov_b32 v40, v80
 v_mul_f32 v42, v80, v112
 v_mov_b32 v41, v96
 v_mul_f32 v43, v96, v112
 v_add_f32 v40, v40, v81
 v_fmac_f32 v42, v81, v113
 v_add_f32 v41, v41, v97
 v_fmac_f32 v43, v97, v113
 v_add_f32 v40, v40, v82
 v_fmac_f32 v42, v82, v114
 v_add_f32 v41, v41, v98
 v_fmac_f32 v43, v98, v114
 v_add_f32 v40, v40, v83
 v_fmac_f32 v42, v83, v115
 v_add_f32 v41, v41, v99
 v_fmac_f32 v43, v99, v115
 v_add_f32 v40, v40, v84
 v_fmac_f32 v42, v84, v116
 v_add_f32 v41, v41, v100
 v_fmac_f32 v43, v100, v116
 v_add_f32 v40, v40, v85
 v_fmac_f32 v42, v85, v117
 v_add_f32 v41, v41, v101
 v_fmac_f32 v43, v101, v117
 v_add_f32 v40, v40, v86
 v_fmac_f32 v42, v86, v118
 v_add_f32 v41, v41, v102
 v_fmac_f32 v43, v102, v118
 v_add_f32 v40, v40, v87
 v_fmac_f32 v42, v87, v119
 v_add_f32 v41, v41, v103
 v_fmac_f32 v43, v103, v119
 v_add_f32 v40, v40, v88
 v_fmac_f32 v42, v88, v120
 v_add_f32 v41, v41, v104
 v_fmac_f32 v43, v104, v120
 v_add_f32 v40, v40, v89
 v_fmac_f32 v42, v89, v121
 v_add_f32 v41, v41, v105
 v_fmac_f32 v43, v105, v121
 v_add_f32 v40, v40, v90
 v_fmac_f32 v42, v90, v122
 v_add_f32 v41, v41, v106
 v_fmac_f32 v43, v106, v122
 v_add_f32 v40, v40, v91
 v_fmac_f32 v42, v91, v123
 v_add_f32 v41, v41, v107
 v_fmac_f32 v43, v107, v123
 v_add_f32 v40, v40, v92
 v_fmac_f32 v42, v92, v124
 v_add_f32 v41, v41, v108
 v_fmac_f32 v43, v108, v124
 v_add_f32 v40, v40, v93
 v_fmac_f32 v42, v93, v125
 v_add_f32 v41, v41, v109
 v_fmac_f32 v43, v109, v125
 v_add_f32 v40, v40, v94
 v_fmac_f32 v42, v94, v126
 v_add_f32 v41, v41, v110
 v_fmac_f32 v43, v110, v126
 v_add_f32 v40, v40, v95
 v_fmac_f32 v42, v95, v127
 v_add_f32 v41, v41, v111
 v_fmac_f32 v43, v111, v127
 v_add_f32_dpp v40, v40, v40 quad_perm:[1,0,3,2] row_mask:0xf bank_mask:0xf
 v_add_f32_dpp v41, v41, v41 quad_perm:[1,0,3,2] row_mask:0xf bank_mask:0xf
 v_add_f32_dpp v42, v42, v42 quad_perm:[1,0,3,2] row_mask:0xf bank_mask:0xf
 v_add_f32_dpp v43, v43, v43 quad_perm:[1,0,3,2] row_mask:0xf bank_mask:0xf
 v_add_f32_dpp v40, v40, v40 quad_perm:[2,3,0,1] row_mask:0xf bank_mask:0xf
 v_add_f32_dpp v41, v41, v41 quad_perm:[2,3,0,1] row_mask:0xf bank_mask:0xf
 v_add_f32_dpp v42, v42, v42 quad_perm:[2,3,0,1] row_mask:0xf bank_mask:0xf
 v_add_f32_dpp v43, v43, v43 quad_perm:[2,3,0,1] row_mask:0xf bank_mask:0xf
 v_add_f32_dpp v40, v40, v40 row_half_mirror row_mask:0xf bank_mask:0xf
 v_add_f32_dpp v41, v41, v41 row_half_mirror row_mask:0xf bank_mask:0xf
 v_add_f32_dpp v42, v42, v42 row_half_mirror row_mask:0xf bank_mask:0xf
 v_add_f32_dpp v43, v43, v43 row_half_mirror row_mask:0xf bank_mask:0xf
 v_add_f32_dpp v40, v40, v40 row_mirror row_mask:0xf bank_mask:0xf
 v_add_f32_dpp v41, v41, v41 row_mirror row_mask:0xf bank_mask:0xf
 v_add_f32_dpp v42, v42, v42 row_mirror row_mask:0xf bank_mask:0xf
 v_add_f32_dpp v43, v43, v43 row_mirror row_mask:0xf bank_mask:0xf
 ds_swizzle_b32 v46, v40 offset:0x401F
 ds_swizzle_b32 v47, v41 offset:0x401F
 ds_swizzle_b32 v48, v42 offset:0x401F
 ds_swizzle_b32 v49, v43 offset:0x401F
 s_waitcnt lgkmcnt(0)
 v_add_f32 v40, v40, v46
 v_add_f32 v41, v41, v47
 v_add_f32 v42, v42, v48
 v_add_f32 v43, v43, v49
 v_mul_f32 v40, 0.002232142857142857, v40
 v_mul_f32 v42, -1.4426950408889634, v42
 v_mov_b32 v128, 0
 v_exp_f32 v42, v42
 v_mul_f32 v41, 0.002232142857142857, v41
 v_mul_f32 v43, -1.4426950408889634, v43
 v_mov_b32 v129, 0
 v_exp_f32 v43, v43
 v_sub_f32 v80, v80, v40
 v_sub_f32 v96, v96, v41
 v_fmac_f32 v128, v80, v80
 v_fmac_f32 v129, v96, v96
 v_sub_f32 v81, v81, v40
 v_sub_f32 v97, v97, v41
 v_fmac_f32 v128, v81, v81
 v_fmac_f32 v129, v97, v97
 v_sub_f32 v82, v82, v40
 v_sub_f32 v98, v98, v41
 v_fmac_f32 v128, v82, v82
 v_fmac_f32 v129, v98, v98
 v_sub_f32 v83, v83, v40
 v_sub_f32 v99, v99, v41
 v_fmac_f32 v128, v83, v83
 v_fmac_f32 v129, v99, v99
 v_sub_f32 v84, v84, v40
 v_sub_f32 v100, v100, v41
 v_fmac_f32 v128, v84, v84
 v_fmac_f32 v129, v100, v100
 v_sub_f32 v85, v85, v40
 v_sub_f32 v101, v101, v41
 v_fmac_f32 v128, v85, v85
 v_fmac_f32 v129, v101, v101
 v_sub_f32 v86, v86, v40
 v_sub_f32 v102, v102, v41
 v_fmac_f32 v128, v86, v86
 v_fmac_f32 v129, v102, v102
 v_sub_f32 v87, v87, v40
 v_sub_f32 v103, v103, v41
 v_fmac_f32 v128, v87, v87
 v_fmac_f32 v129, v103, v103
 v_sub_f32 v88, v88, v40
 v_sub_f32 v104, v104, v41
 v_fmac_f32 v128, v88, v88
 v_fmac_f32 v129, v104, v104
 v_sub_f32 v89, v89, v40
 v_sub_f32 v105, v105, v41
 v_fmac_f32 v128, v89, v89
 v_fmac_f32 v129, v105, v105
 v_sub_f32 v90, v90, v40
 v_sub_f32 v106, v106, v41
 v_fmac_f32 v128, v90, v90
 v_fmac_f32 v129, v106, v106
 v_sub_f32 v91, v91, v40
 v_sub_f32 v107, v107, v41
 v_fmac_f32 v128, v91, v91
 v_fmac_f32 v129, v107, v107
 v_sub_f32 v92, v92, v40
 v_sub_f32 v108, v108, v41
 v_fmac_f32 v128, v92, v92
 v_fmac_f32 v129, v108, v108
 v_sub_f32 v93, v93, v40
 v_sub_f32 v109, v109, v41
 v_fmac_f32 v128, v93, v93
 v_fmac_f32 v129, v109, v109
 v_sub_f32 v94, v94, v40
 v_sub_f32 v110, v110, v41
 v_fmac_f32 v128, v94, v94
 v_fmac_f32 v129, v110, v110
 v_sub_f32 v95, v95, v40
 v_sub_f32 v111, v111, v41
 v_fmac_f32 v128, v95, v95
 v_fmac_f32 v129, v111, v111
 v_cndmask_b32 v128, 0, v128, vcc
 v_add_f32 v42, 1.0, v42
 v_rcp_f32 v42, v42
 v_cndmask_b32 v129, 0, v129, vcc
 v_add_f32 v43, 1.0, v43
 v_rcp_f32 v43, v43
 v_add_f32_dpp v128, v128, v128 quad_perm:[1,0,3,2] row_mask:0xf bank_mask:0xf
 v_add_f32_dpp v129, v129, v129 quad_perm:[1,0,3,2] row_mask:0xf bank_mask:0xf
 s_nop 0
 v_add_f32_dpp v128, v128, v128 quad_perm:[2,3,0,1] row_mask:0xf bank_mask:0xf
 v_add_f32_dpp v129, v129, v129 quad_perm:[2,3,0,1] row_mask:0xf bank_mask:0xf
 s_nop 0
 v_add_f32_dpp v128, v128, v128 row_half_mirror row_mask:0xf bank_mask:0xf
 v_add_f32_dpp v129, v129, v129 row_half_mirror row_mask:0xf bank_mask:0xf
 s_nop 0
 v_add_f32_dpp v128, v128, v128 row_mirror row_mask:0xf bank_mask:0xf
 v_add_f32_dpp v129, v129, v129 row_mirror row_mask:0xf bank_mask:0xf
 ds_swizzle_b32 v134, v128 offset:0x401F
 ds_swizzle_b32 v135, v129 offset:0x401F
 s_waitcnt lgkmcnt(0)
 v_add_f32 v128, v128, v134
 v_add_f32 v129, v129, v135
 v_mov_b32 v40, 1e-5
 v_fmac_f32 v40, 0.002232142857142857, v128
 v_rsq_f32 v40, v40
 v_mov_b32 v41, 1e-5
 v_fmac_f32 v41, 0.002232142857142857, v129
 v_rsq_f32 v41, v41
 v_and_b32 v9, 15, v50
 v_mul_u32_u24 v8, 896, v9
 v_lshl_add_u32 v8, v3, 4, v8
 v_add_u32 v8, 107520, v8
 v_lshlrev_b32 v9, 2, v9
 v_add_u32 v9, 162880, v9
 ds_write_b32 v9, v42
 ds_write_b32 v9, v43 offset:8
 v_mul_f32 v80, v80, v40
 v_mul_f32 v81, v81, v40
 v_mul_f32 v82, v82, v40
 v_mul_f32 v83, v83, v40
 v_mul_f32 v84, v84, v40
 v_mul_f32 v85, v85, v40
 v_mul_f32 v86, v86, v40
 v_mul_f32 v87, v87, v40
 v_mul_f32 v88, v88, v40
 v_mul_f32 v89, v89, v40
 v_mul_f32 v90, v90, v40
 v_mul_f32 v91, v91, v40
 v_mul_f32 v92, v92, v40
 v_mul_f32 v93, v93, v40
 v_mul_f32 v94, v94, v40
 v_mul_f32 v95, v95, v40
 v_mul_f32 v96, v96, v41
 v_mul_f32 v97, v97, v41
 v_mul_f32 v98, v98, v41
 v_mul_f32 v99, v99, v41
 v_mul_f32 v100, v100, v41
 v_mul_f32 v101, v101, v41
 v_mul_f32 v102, v102, v41
 v_mul_f32 v103, v103, v41
 v_mul_f32 v104, v104, v41
 v_mul_f32 v105, v105, v41
 v_mul_f32 v106, v106, v41
 v_mul_f32 v107, v107, v41
 v_mul_f32 v108, v108, v41
 v_mul_f32 v109, v109, v41
 v_mul_f32 v110, v110, v41
 v_mul_f32 v111, v111, v41
 v_cvt_pk_bf16_f32 v52, v80, v81
 v_cvt_pk_bf16_f32 v53, v82, v83
 v_cvt_pk_bf16_f32 v54, v84, v85
 v_cvt_pk_bf16_f32 v55, v86, v87
 v_cvt_pk_bf16_f32 v56, v88, v89
 v_cvt_pk_bf16_f32 v57, v90, v91
 v_cvt_pk_bf16_f32 v58, v92, v93
 v_cvt_pk_bf16_f32 v59, v94, v95
 v_cvt_pk_bf16_f32 v60, v96, v97
 v_cvt_pk_bf16_f32 v61, v98, v99
 v_cvt_pk_bf16_f32 v62, v100, v101
 v_cvt_pk_bf16_f32 v63, v102, v103
 v_cvt_pk_bf16_f32 v64, v104, v105
 v_cvt_pk_bf16_f32 v65, v106, v107
 v_cvt_pk_bf16_f32 v66, v108, v109
 v_cvt_pk_bf16_f32 v67, v110, v111
 s_mov_b64 exec, vcc
 ds_write_b128 v8, v[52:55] offset:0
 ds_write_b128 v8, v[56:59] offset:448
 ds_write_b128 v8, v[60:63] offset:1792
 ds_write_b128 v8, v[64:67] offset:2240
 s_waitcnt lgkmcnt(0)
 s_mov_b64 exec, 1
 v_mov_b32 v8, 162864
 v_mov_b32 v9, 1
 ds_add_u32 v8, v9
 s_mov_b64 exec, -1
 v_lshl_add_u32 v7, v2, 3, v4
 v_mul_u32_u24 v7, 896, v7
 s_lshl_b32 s37, s5, 7
 v_add3_u32 v7, v7, v5, s37
 v_add_u32 v7, 107520, v7
 s_add_u32 s49, s5, 4
 s_min_u32 s49, s49, 6
 s_sub_u32 s49, s49, s5
 s_lshl_b32 s42, s49, 7
 v_add_u32 v40, s42, v7
 s_add_u32 s37, s37, s36
 v_and_b32 v41, 15, v1
 v_lshlrev_b32 v41, 2, v41
 v_add_u32 v42, 162880, v41
 v_lshlrev_b32 v43, 4, v1
 v_mov_b32 v8, 162864
 s_mov_b32 s43, 0x400000
L_ll10:
 ds_read_b32 v9, v8
 s_waitcnt lgkmcnt(0)
 v_cmp_gt_u32 vcc, 4, v9
 s_sub_u32 s43, s43, 1
 s_cbranch_scc1 L_ld10
 s_cbranch_vccz L_ld10
 s_sleep 1
 s_branch L_ll10
L_ld10:
 ds_read_b64_tr_b16 v[52:53], v7 offset:0
 ds_read_b64_tr_b16 v[54:55], v7 offset:3584
 ds_read_b64_tr_b16 v[56:57], v7 offset:64
 ds_read_b64_tr_b16 v[58:59], v7 offset:3648
 ds_read_b64_tr_b16 v[60:61], v40 offset:0
 ds_read_b64_tr_b16 v[62:63], v40 offset:3584
 ds_read_b64_tr_b16 v[64:65], v40 offset:64
 ds_read_b64_tr_b16 v[66:67], v40 offset:3648
 ds_read_b32 v42, v42
 s_lshl_b32 s42, s37, 11
 s_add_u32 s42, s42, 2621440
 s_lshl_b32 s43, s49, 18
 s_add_u32 s43, s43, s42
 s_lshl_b32 s36, s36, 6
 s_add_u32 s36, s36, 8912896
 s_waitcnt lgkmcnt(0)
 buffer_store_dwordx4 v[52:55], v43, s[12:15], s42 offen offset:0 sc1
 buffer_store_dwordx4 v[56:59], v43, s[12:15], s42 offen offset:1024 sc1
 buffer_store_dwordx4 v[60:63], v43, s[12:15], s43 offen offset:0 sc1
 buffer_store_dwordx4 v[64:67], v43, s[12:15], s43 offen offset:1024 sc1
 buffer_store_dword v42, v41, s[12:15], s36 offen offset:0 sc1
 s_mov_b32 s43, 0x40000
 v_mov_b32 v8, 0
L_nl11:
 v_readfirstlane_b32 s60, v255
 s_cmp_lg_u32 s60, 0
 s_cbranch_scc1 L_nd11
 s_sub_u32 s43, s43, 1
 s_cbranch_scc1 L_nd11
 buffer_load_dword v255, v8, s[56:59], 0 offen offset:0 sc1
 s_waitcnt vmcnt(0)
 s_branch L_nl11
L_nd11:
 s_lshl_b32 s37, s37, 7
 s_add_u32 s37, s37, 9699328
 s_lshl_b32 s49, s49, 14
 v_mul_u32_u24 v8, s49, v1
 v_mov_b32 v9, s60
 s_waitcnt vmcnt(0)
 s_mov_b64 exec, 3
 buffer_store_dword v9, v8, s[12:15], s37 offen offset:0 sc1
 s_mov_b64 exec, -1
L_w1p:
 v_mov_b32 v8, 162848
 s_mov_b32 s43, 0x400000
L_ll12:
 ds_read_b32 v9, v8
 s_waitcnt lgkmcnt(0)
 v_cmp_gt_u32 vcc, 4, v9
 s_sub_u32 s43, s43, 1
 s_cbranch_scc1 L_ld12
 s_cbranch_vccz L_ld12
 s_sleep 1
 s_branch L_ll12
L_ld12:
 s_mul_i32 s42, s44, 7
 s_lshr_b32 s42, s42, 1
 s_lshl_b32 s42, s42, 7
 s_lshl_b32 s43, s45, 2
 s_add_u32 s43, s43, s5
 s_mul_i32 s43, s43, 57344
 s_add_u32 s42, s42, s43
 v_lshrrev_b32 v7, 2, v1
 v_mul_u32_u24 v7, 3584, v7
 v_lshl_add_u32 v7, v6, 7, v7
 buffer_load_dword v254, v7, s[8:11], s42 offen offset:0
 s_cmp_lt_u32 s45, 24
 s_cbranch_scc1 L_gp_done
 s_add_u32 s42, s42, 917504
 buffer_load_dword v253, v7, s[8:11], s42 offen offset:0
 s_branch L_gp_done
L_kv:
 s_cmp_eq_u32 s6, 1
 s_cselect_b32 s32, s62, s32
 s_cselect_b32 s33, s63, s33
 s_mul_i32 s36, s6, 26624
 s_add_u32 s36, s36, 107520
 s_lshl_b32 s37, s7, 10
 s_add_u32 m0, s36, s37
 v_lshl_add_u32 v7, v1, 4, s37
 buffer_load_dwordx4 v7, s[32:35], 0 offen offset:0  lds
 s_add_u32 m0, m0, 2048
 v_add_u32 v7, 2048, v7
 buffer_load_dwordx4 v7, s[32:35], 0 offen offset:0  lds
 s_add_u32 m0, m0, 2048
 v_add_u32 v7, 2048, v7
 buffer_load_dwordx4 v7, s[32:35], 0 offen offset:0  lds
 s_add_u32 m0, m0, 2048
 v_add_u32 v7, 2048, v7
 buffer_load_dwordx4 v7, s[32:35], 0 offen offset:0  lds
 s_add_u32 m0, m0, 2048
 v_add_u32 v7, 2048, v7
 buffer_load_dwordx4 v7, s[32:35], 0 offen offset:0  lds
 s_add_u32 m0, m0, 2048
 v_add_u32 v7, 2048, v7
 buffer_load_dwordx4 v7, s[32:35], 0 offen offset:0  lds
 s_add_u32 m0, m0, 2048
 v_add_u32 v7, 2048, v7
 buffer_load_dwordx4 v7, s[32:35], 0 offen offset:0  lds
 s_add_u32 m0, m0, 2048
 v_add_u32 v7, 2048, v7
 buffer_load_dwordx4 v7, s[32:35], 0 offen offset:0  lds
 s_add_u32 m0, m0, 2048
 v_add_u32 v7, 2048, v7
 buffer_load_dwordx4 v7, s[32:35], 0 offen offset:0  lds
 s_add_u32 m0, m0, 2048
 v_add_u32 v7, 2048, v7
 buffer_load_dwordx4 v7, s[32:35], 0 offen offset:0  lds
 s_add_u32 m0, m0, 2048
 v_add_u32 v7, 2048, v7
 buffer_load_dwordx4 v7, s[32:35], 0 offen offset:0  lds
 s_add_u32 m0, m0, 2048
 v_add_u32 v7, 2048, v7
 buffer_load_dwordx4 v7, s[32:35], 0 offen offset:0  lds
 s_add_u32 m0, m0, 2048
 v_add_u32 v7, 2048, v7
 buffer_load_dwordx4 v7, s[32:35], 0 offen offset:0  lds
 s_add_u32 m0, m0, 2048
 v_add_u32 v7, 2048, v7
 v_lshl_add_u32 v7, s7, 5, v3
 v_bfe_u32 v8, v7, 1, 3
 v_mul_u32_u24 v7, 896, v7
 v_or_b32 v9, 0, v2
 v_xor_b32 v9, v9, v8
 v_lshl_add_u32 v10, v9, 4, v7
 v_or_b32 v9, 2, v2
 v_xor_b32 v9, v9, v8
 v_lshl_add_u32 v11, v9, 4, v7
 v_or_b32 v9, 4, v2
 v_xor_b32 v9, v9, v8
 v_lshl_add_u32 v12, v9, 4, v7
 v_or_b32 v9, 6, v2
 v_xor_b32 v9, v9, v8
 v_lshl_add_u32 v13, v9, 4, v7
 v_lshl_add_u32 v14, v2, 3, v4
 v_mul_u32_u24 v14, 56, v14
 v_add3_u32 v14, v14, v5, s36
 s_lshl_b32 s36, s3, 1
 s_add_u32 s36, s36, s7
 s_lshl_b32 s36, s36, 1
 s_add_u32 s36, s36, s6
 s_lshl_b32 s37, s36, 7
 s_add_u32 s37, s37, 9830400
 s_lshl_b32 s36, s36, 11
 s_add_u32 s36, s36, 2097152
 s_waitcnt vmcnt(0)
 s_waitcnt lgkmcnt(0)
 s_mov_b64 exec, 1
 v_mov_b32 v8, 162868
 v_mov_b32 v9, 1
 ds_add_u32 v8, v9
 s_mov_b64 exec, -1
 v_mov_b32 v8, 162868
 s_mov_b32 s43, 0x400000
L_ll13:
 ds_read_b32 v9, v8
 s_waitcnt lgkmcnt(0)
 v_cmp_gt_u32 vcc, 4, v9
 s_sub_u32 s43, s43, 1
 s_cbranch_scc1 L_ld13
 s_cbranch_vccz L_ld13
 s_sleep 1
 s_branch L_ll13
L_ld13:
 v_mov_b32 v8, 162872
 s_mov_b32 s43, 0x400000
L_ll14:
 ds_read_b32 v9, v8
 s_waitcnt lgkmcnt(0)
 v_cmp_gt_u32 vcc, 4, v9
 s_sub_u32 s43, s43, 1
 s_cbranch_scc1 L_ld14
 s_cbranch_vccz L_ld14
 s_sleep 1
 s_branch L_ll14
L_ld14:
 s_cmp_eq_u32 s6, 1
 s_cbranch_scc1 L_vv
 ds_read_b128 v[16:19], v10 offset:0
 ds_read_b64_tr_b16 v[20:21], v14 offset:0
 ds_read_b64_tr_b16 v[22:23], v14 offset:224
 ds_read_b128 v[24:27], v11 offset:0
 ds_read_b64_tr_b16 v[28:29], v14 offset:896
 ds_read_b64_tr_b16 v[30:31], v14 offset:1120
 ds_read_b128 v[32:35], v12 offset:0
 ds_read_b64_tr_b16 v[36:37], v14 offset:1792
 ds_read_b64_tr_b16 v[38:39], v14 offset:2016
 ds_read_b128 v[40:43], v13 offset:0
 ds_read_b64_tr_b16 v[44:45], v14 offset:2688
 ds_read_b64_tr_b16 v[46:47], v14 offset:2912
 s_waitcnt lgkmcnt(9)
 v_mfma_f32_32x32x16_bf16 v[64:79], v[20:23], v[16:19], 0
 ds_read_b128 v[16:19], v10 offset:128
 ds_read_b64_tr_b16 v[20:21], v14 offset:3584
 ds_read_b64_tr_b16 v[22:23], v14 offset:3808
 s_waitcnt lgkmcnt(9)
 v_mfma_f32_32x32x16_bf16 v[64:79], v[28:31], v[24:27], v[64:79]
 ds_read_b128 v[24:27], v11 offset:128
 ds_read_b64_tr_b16 v[28:29], v14 offset:4480
 ds_read_b64_tr_b16 v[30:31], v14 offset:4704
 s_waitcnt lgkmcnt(9)
 v_mfma_f32_32x32x16_bf16 v[64:79], v[36:39], v[32:35], v[64:79]
 ds_read_b128 v[32:35], v12 offset:128
 ds_read_b64_tr_b16 v[36:37], v14 offset:5376
 ds_read_b64_tr_b16 v[38:39], v14 offset:5600
 s_waitcnt lgkmcnt(9)
 v_mfma_f32_32x32x16_bf16 v[64:79], v[44:47], v[40:43], v[64:79]
 ds_read_b128 v[40:43], v13 offset:128
 ds_read_b64_tr_b16 v[44:45], v14 offset:6272
 ds_read_b64_tr_b16 v[46:47], v14 offset:6496
 s_waitcnt lgkmcnt(9)
 v_mfma_f32_32x32x16_bf16 v[64:79], v[20:23], v[16:19], v[64:79]
 ds_read_b128 v[16:19], v10 offset:256
 ds_read_b64_tr_b16 v[20:21], v14 offset:7168
 ds_read_b64_tr_b16 v[22:23], v14 offset:7392
 s_waitcnt lgkmcnt(9)
 v_mfma_f32_32x32x16_bf16 v[64:79], v[28:31], v[24:27], v[64:79]
 ds_read_b128 v[24:27], v11 offset:256
 ds_read_b64_tr_b16 v[28:29], v14 offset:8064
 ds_read_b64_tr_b16 v[30:31], v14 offset:8288
 s_waitcnt lgkmcnt(9)
 v_mfma_f32_32x32x16_bf16 v[64:79], v[36:39], v[32:35], v[64:79]
 ds_read_b128 v[32:35], v12 offset:256
 ds_read_b64_tr_b16 v[36:37], v14 offset:8960
 ds_read_b64_tr_b16 v[38:39], v14 offset:9184
 s_waitcnt lgkmcnt(9)
 v_mfma_f32_32x32x16_bf16 v[64:79], v[44:47], v[40:43], v[64:79]
 ds_read_b128 v[40:43], v13 offset:256
 ds_read_b64_tr_b16 v[44:45], v14 offset:9856
 ds_read_b64_tr_b16 v[46:47], v14 offset:10080
 s_waitcnt lgkmcnt(9)
 v_mfma_f32_32x32x16_bf16 v[64:79], v[20:23], v[16:19], v[64:79]
 ds_read_b128 v[16:19], v10 offset:384
 ds_read_b64_tr_b16 v[20:21], v14 offset:10752
 ds_read_b64_tr_b16 v[22:23], v14 offset:10976
 s_waitcnt lgkmcnt(9)
 v_mfma_f32_32x32x16_bf16 v[64:79], v[28:31], v[24:27], v[64:79]
 ds_read_b128 v[24:27], v11 offset:384
 ds_read_b64_tr_b16 v[28:29], v14 offset:11648
 ds_read_b64_tr_b16 v[30:31], v14 offset:11872
 s_waitcnt lgkmcnt(9)
 v_mfma_f32_32x32x16_bf16 v[64:79], v[36:39], v[32:35], v[64:79]
 ds_read_b128 v[32:35], v12 offset:384
 ds_read_b64_tr_b16 v[36:37], v14 offset:12544
 ds_read_b64_tr_b16 v[38:39], v14 offset:12768
 s_waitcnt lgkmcnt(9)
 v_mfma_f32_32x32x16_bf16 v[64:79], v[44:47], v[40:43], v[64:79]
 ds_read_b128 v[40:43], v13 offset:384
 ds_read_b64_tr_b16 v[44:45], v14 offset:13440
 ds_read_b64_tr_b16 v[46:47], v14 offset:13664
 s_waitcnt lgkmcnt(9)
 v_mfma_f32_32x32x16_bf16 v[64:79], v[20:23], v[16:19], v[64:79]
 ds_read_b128 v[16:19], v10 offset:512
 ds_read_b64_tr_b16 v[20:21], v14 offset:14336
 ds_read_b64_tr_b16 v[22:23], v14 offset:14560
 s_waitcnt lgkmcnt(9)
 v_mfma_f32_32x32x16_bf16 v[64:79], v[28:31], v[24:27], v[64:79]
 ds_read_b128 v[24:27], v11 offset:512
 ds_read_b64_tr_b16 v[28:29], v14 offset:15232
 ds_read_b64_tr_b16 v[30:31], v14 offset:15456
 s_waitcnt lgkmcnt(9)
 v_mfma_f32_32x32x16_bf16 v[64:79], v[36:39], v[32:35], v[64:79]
 ds_read_b128 v[32:35], v12 offset:512
 ds_read_b64_tr_b16 v[36:37], v14 offset:16128
 ds_read_b64_tr_b16 v[38:39], v14 offset:16352
 s_waitcnt lgkmcnt(9)
 v_mfma_f32_32x32x16_bf16 v[64:79], v[44:47], v[40:43], v[64:79]
 ds_read_b128 v[40:43], v13 offset:512
 ds_read_b64_tr_b16 v[44:45], v14 offset:17024
 ds_read_b64_tr_b16 v[46:47], v14 offset:17248
 s_waitcnt lgkmcnt(9)
 v_mfma_f32_32x32x16_bf16 v[64:79], v[20:23], v[16:19], v[64:79]
 ds_read_b128 v[16:19], v10 offset:640
 ds_read_b64_tr_b16 v[20:21], v14 offset:17920
 ds_read_b64_tr_b16 v[22:23], v14 offset:18144
 s_waitcnt lgkmcnt(9)
 v_mfma_f32_32x32x16_bf16 v[64:79], v[28:31], v[24:27], v[64:79]
 ds_read_b128 v[24:27], v11 offset:640
 ds_read_b64_tr_b16 v[28:29], v14 offset:18816
 ds_read_b64_tr_b16 v[30:31], v14 offset:19040
 s_waitcnt lgkmcnt(9)
 v_mfma_f32_32x32x16_bf16 v[64:79], v[36:39], v[32:35], v[64:79]
 ds_read_b128 v[32:35], v12 offset:640
 ds_read_b64_tr_b16 v[36:37], v14 offset:19712
 ds_read_b64_tr_b16 v[38:39], v14 offset:19936
 s_waitcnt lgkmcnt(9)
 v_mfma_f32_32x32x16_bf16 v[64:79], v[44:47], v[40:43], v[64:79]
 ds_read_b128 v[40:43], v13 offset:640
 ds_read_b64_tr_b16 v[44:45], v14 offset:20608
 ds_read_b64_tr_b16 v[46:47], v14 offset:20832
 s_waitcnt lgkmcnt(9)
 v_mfma_f32_32x32x16_bf16 v[64:79], v[20:23], v[16:19], v[64:79]
 ds_read_b128 v[16:19], v10 offset:768
 ds_read_b64_tr_b16 v[20:21], v14 offset:21504
 ds_read_b64_tr_b16 v[22:23], v14 offset:21728
 s_waitcnt lgkmcnt(9)
 v_mfma_f32_32x32x16_bf16 v[64:79], v[28:31], v[24:27], v[64:79]
 ds_read_b128 v[24:27], v11 offset:768
 ds_read_b64_tr_b16 v[28:29], v14 offset:22400
 ds_read_b64_tr_b16 v[30:31], v14 offset:22624
 s_waitcnt lgkmcnt(9)
 v_mfma_f32_32x32x16_bf16 v[64:79], v[36:39], v[32:35], v[64:79]
 ds_read_b128 v[32:35], v12 offset:768
 ds_read_b64_tr_b16 v[36:37], v14 offset:23296
 ds_read_b64_tr_b16 v[38:39], v14 offset:23520
 s_waitcnt lgkmcnt(9)
 v_mfma_f32_32x32x16_bf16 v[64:79], v[44:47], v[40:43], v[64:79]
 ds_read_b128 v[40:43], v13 offset:768
 ds_read_b64_tr_b16 v[44:45], v14 offset:24192
 ds_read_b64_tr_b16 v[46:47], v14 offset:24416
 s_waitcnt lgkmcnt(9)
 v_mfma_f32_32x32x16_bf16 v[64:79], v[20:23], v[16:19], v[64:79]
 s_waitcnt lgkmcnt(6)
 v_mfma_f32_32x32x16_bf16 v[64:79], v[28:31], v[24:27], v[64:79]
 s_waitcnt lgkmcnt(3)
 v_mfma_f32_32x32x16_bf16 v[64:79], v[36:39], v[32:35], v[64:79]
 s_waitcnt lgkmcnt(0)
 v_mfma_f32_32x32x16_bf16 v[64:79], v[44:47], v[40:43], v[64:79]
 s_nop 7
 s_nop 7
 v_cmp_gt_u32 vcc, 32, v1
 v_mov_b32 v8, 0x3f803f80
 v_mov_b32 v9, 0x3f80
 v_cvt_pk_bf16_f32 v16, v64, v65
 v_cvt_pk_bf16_f32 v17, v66, v67
 v_cvt_pk_bf16_f32 v18, v68, v69
 v_cvt_pk_bf16_f32 v19, v70, v71
 v_cvt_pk_bf16_f32 v20, v72, v73
 v_cvt_pk_bf16_f32 v21, v74, v75
 v_cvt_pk_bf16_f32 v22, v76, v77
 v_cvt_pk_bf16_f32 v23, v78, v79
 v_cndmask_b32 v22, v8, v22, vcc
 v_cndmask_b32 v23, v9, v23, vcc
 s_branch L_st2
L_vv:
 ds_read_b128 v[16:19], v10 offset:0
 ds_read_b64_tr_b16 v[20:21], v14 offset:0
 ds_read_b64_tr_b16 v[22:23], v14 offset:224
 ds_read_b128 v[24:27], v11 offset:0
 ds_read_b64_tr_b16 v[28:29], v14 offset:896
 ds_read_b64_tr_b16 v[30:31], v14 offset:1120
 ds_read_b128 v[32:35], v12 offset:0
 ds_read_b64_tr_b16 v[36:37], v14 offset:1792
 ds_read_b64_tr_b16 v[38:39], v14 offset:2016
 ds_read_b128 v[40:43], v13 offset:0
 ds_read_b64_tr_b16 v[44:45], v14 offset:2688
 ds_read_b64_tr_b16 v[46:47], v14 offset:2912
 s_waitcnt lgkmcnt(9)
 v_mfma_f32_32x32x16_bf16 v[64:79], v[16:19], v[20:23], 0
 ds_read_b128 v[16:19], v10 offset:128
 ds_read_b64_tr_b16 v[20:21], v14 offset:3584
 ds_read_b64_tr_b16 v[22:23], v14 offset:3808
 s_waitcnt lgkmcnt(9)
 v_mfma_f32_32x32x16_bf16 v[64:79], v[24:27], v[28:31], v[64:79]
 ds_read_b128 v[24:27], v11 offset:128
 ds_read_b64_tr_b16 v[28:29], v14 offset:4480
 ds_read_b64_tr_b16 v[30:31], v14 offset:4704
 s_waitcnt lgkmcnt(9)
 v_mfma_f32_32x32x16_bf16 v[64:79], v[32:35], v[36:39], v[64:79]
 ds_read_b128 v[32:35], v12 offset:128
 ds_read_b64_tr_b16 v[36:37], v14 offset:5376
 ds_read_b64_tr_b16 v[38:39], v14 offset:5600
 s_waitcnt lgkmcnt(9)
 v_mfma_f32_32x32x16_bf16 v[64:79], v[40:43], v[44:47], v[64:79]
 ds_read_b128 v[40:43], v13 offset:128
 ds_read_b64_tr_b16 v[44:45], v14 offset:6272
 ds_read_b64_tr_b16 v[46:47], v14 offset:6496
 s_waitcnt lgkmcnt(9)
 v_mfma_f32_32x32x16_bf16 v[64:79], v[16:19], v[20:23], v[64:79]
 ds_read_b128 v[16:19], v10 offset:256
 ds_read_b64_tr_b16 v[20:21], v14 offset:7168
 ds_read_b64_tr_b16 v[22:23], v14 offset:7392
 s_waitcnt lgkmcnt(9)
 v_mfma_f32_32x32x16_bf16 v[64:79], v[24:27], v[28:31], v[64:79]
 ds_read_b128 v[24:27], v11 offset:256
 ds_read_b64_tr_b16 v[28:29], v14 offset:8064
 ds_read_b64_tr_b16 v[30:31], v14 offset:8288
 s_waitcnt lgkmcnt(9)
 v_mfma_f32_32x32x16_bf16 v[64:79], v[32:35], v[36:39], v[64:79]
 ds_read_b128 v[32:35], v12 offset:256
 ds_read_b64_tr_b16 v[36:37], v14 offset:8960
 ds_read_b64_tr_b16 v[38:39], v14 offset:9184
 s_waitcnt lgkmcnt(9)
 v_mfma_f32_32x32x16_bf16 v[64:79], v[40:43], v[44:47], v[64:79]
 ds_read_b128 v[40:43], v13 offset:256
 ds_read_b64_tr_b16 v[44:45], v14 offset:9856
 ds_read_b64_tr_b16 v[46:47], v14 offset:10080
 s_waitcnt lgkmcnt(9)
 v_mfma_f32_32x32x16_bf16 v[64:79], v[16:19], v[20:23], v[64:79]
 ds_read_b128 v[16:19], v10 offset:384
 ds_read_b64_tr_b16 v[20:21], v14 offset:10752
 ds_read_b64_tr_b16 v[22:23], v14 offset:10976
 s_waitcnt lgkmcnt(9)
 v_mfma_f32_32x32x16_bf16 v[64:79], v[24:27], v[28:31], v[64:79]
 ds_read_b128 v[24:27], v11 offset:384
 ds_read_b64_tr_b16 v[28:29], v14 offset:11648
 ds_read_b64_tr_b16 v[30:31], v14 offset:11872
 s_waitcnt lgkmcnt(9)
 v_mfma_f32_32x32x16_bf16 v[64:79], v[32:35], v[36:39], v[64:79]
 ds_read_b128 v[32:35], v12 offset:384
 ds_read_b64_tr_b16 v[36:37], v14 offset:12544
 ds_read_b64_tr_b16 v[38:39], v14 offset:12768
 s_waitcnt lgkmcnt(9)
 v_mfma_f32_32x32x16_bf16 v[64:79], v[40:43], v[44:47], v[64:79]
 ds_read_b128 v[40:43], v13 offset:384
 ds_read_b64_tr_b16 v[44:45], v14 offset:13440
 ds_read_b64_tr_b16 v[46:47], v14 offset:13664
 s_waitcnt lgkmcnt(9)
 v_mfma_f32_32x32x16_bf16 v[64:79], v[16:19], v[20:23], v[64:79]
 ds_read_b128 v[16:19], v10 offset:512
 ds_read_b64_tr_b16 v[20:21], v14 offset:14336
 ds_read_b64_tr_b16 v[22:23], v14 offset:14560
 s_waitcnt lgkmcnt(9)
 v_mfma_f32_32x32x16_bf16 v[64:79], v[24:27], v[28:31], v[64:79]
 ds_read_b128 v[24:27], v11 offset:512
 ds_read_b64_tr_b16 v[28:29], v14 offset:15232
 ds_read_b64_tr_b16 v[30:31], v14 offset:15456
 s_waitcnt lgkmcnt(9)
 v_mfma_f32_32x32x16_bf16 v[64:79], v[32:35], v[36:39], v[64:79]
 ds_read_b128 v[32:35], v12 offset:512
 ds_read_b64_tr_b16 v[36:37], v14 offset:16128
 ds_read_b64_tr_b16 v[38:39], v14 offset:16352
 s_waitcnt lgkmcnt(9)
 v_mfma_f32_32x32x16_bf16 v[64:79], v[40:43], v[44:47], v[64:79]
 ds_read_b128 v[40:43], v13 offset:512
 ds_read_b64_tr_b16 v[44:45], v14 offset:17024
 ds_read_b64_tr_b16 v[46:47], v14 offset:17248
 s_waitcnt lgkmcnt(9)
 v_mfma_f32_32x32x16_bf16 v[64:79], v[16:19], v[20:23], v[64:79]
 ds_read_b128 v[16:19], v10 offset:640
 ds_read_b64_tr_b16 v[20:21], v14 offset:17920
 ds_read_b64_tr_b16 v[22:23], v14 offset:18144
 s_waitcnt lgkmcnt(9)
 v_mfma_f32_32x32x16_bf16 v[64:79], v[24:27], v[28:31], v[64:79]
 ds_read_b128 v[24:27], v11 offset:640
 ds_read_b64_tr_b16 v[28:29], v14 offset:18816
 ds_read_b64_tr_b16 v[30:31], v14 offset:19040
 s_waitcnt lgkmcnt(9)
 v_mfma_f32_32x32x16_bf16 v[64:79], v[32:35], v[36:39], v[64:79]
 ds_read_b128 v[32:35], v12 offset:640
 ds_read_b64_tr_b16 v[36:37], v14 offset:19712
 ds_read_b64_tr_b16 v[38:39], v14 offset:19936
 s_waitcnt lgkmcnt(9)
 v_mfma_f32_32x32x16_bf16 v[64:79], v[40:43], v[44:47], v[64:79]
 ds_read_b128 v[40:43], v13 offset:640
 ds_read_b64_tr_b16 v[44:45], v14 offset:20608
 ds_read_b64_tr_b16 v[46:47], v14 offset:20832
 s_waitcnt lgkmcnt(9)
 v_mfma_f32_32x32x16_bf16 v[64:79], v[16:19], v[20:23], v[64:79]
 ds_read_b128 v[16:19], v10 offset:768
 ds_read_b64_tr_b16 v[20:21], v14 offset:21504
 ds_read_b64_tr_b16 v[22:23], v14 offset:21728
 s_waitcnt lgkmcnt(9)
 v_mfma_f32_32x32x16_bf16 v[64:79], v[24:27], v[28:31], v[64:79]
 ds_read_b128 v[24:27], v11 offset:768
 ds_read_b64_tr_b16 v[28:29], v14 offset:22400
 ds_read_b64_tr_b16 v[30:31], v14 offset:22624
 s_waitcnt lgkmcnt(9)
 v_mfma_f32_32x32x16_bf16 v[64:79], v[32:35], v[36:39], v[64:79]
 ds_read_b128 v[32:35], v12 offset:768
 ds_read_b64_tr_b16 v[36:37], v14 offset:23296
 ds_read_b64_tr_b16 v[38:39], v14 offset:23520
 s_waitcnt lgkmcnt(9)
 v_mfma_f32_32x32x16_bf16 v[64:79], v[40:43], v[44:47], v[64:79]
 ds_read_b128 v[40:43], v13 offset:768
 ds_read_b64_tr_b16 v[44:45], v14 offset:24192
 ds_read_b64_tr_b16 v[46:47], v14 offset:24416
 s_waitcnt lgkmcnt(9)
 v_mfma_f32_32x32x16_bf16 v[64:79], v[16:19], v[20:23], v[64:79]
 s_waitcnt lgkmcnt(6)
 v_mfma_f32_32x32x16_bf16 v[64:79], v[24:27], v[28:31], v[64:79]
 s_waitcnt lgkmcnt(3)
 v_mfma_f32_32x32x16_bf16 v[64:79], v[32:35], v[36:39], v[64:79]
 s_waitcnt lgkmcnt(0)
 v_mfma_f32_32x32x16_bf16 v[64:79], v[40:43], v[44:47], v[64:79]
 s_nop 7
 s_nop 7
 v_cmp_eq_u32 vcc, 28, v3
 v_mov_b32 v8, 0x3f803f80
 s_nop 0
 v_cndmask_b32 v8, 0, v8, vcc
 v_cmp_gt_u32 vcc, 28, v3
 v_cvt_pk_bf16_f32 v16, v64, v65
 v_cvt_pk_bf16_f32 v17, v66, v67
 v_cvt_pk_bf16_f32 v18, v68, v69
 v_cvt_pk_bf16_f32 v19, v70, v71
 v_cvt_pk_bf16_f32 v20, v72, v73
 v_cvt_pk_bf16_f32 v21, v74, v75
 v_cvt_pk_bf16_f32 v22, v76, v77
 v_cvt_pk_bf16_f32 v23, v78, v79
 v_cndmask_b32 v16, v8, v16, vcc
 v_cndmask_b32 v17, v8, v17, vcc
 v_cndmask_b32 v18, v8, v18, vcc
 v_cndmask_b32 v19, v8, v19, vcc
 v_cndmask_b32 v20, v8, v20, vcc
 v_cndmask_b32 v21, v8, v21, vcc
 v_cndmask_b32 v22, v8, v22, vcc
 v_cndmask_b32 v23, v8, v23, vcc
L_st2:
 s_waitcnt lgkmcnt(0)
 s_mov_b64 exec, 1
 v_mov_b32 v8, 162868
 v_mov_b32 v9, 1
 ds_add_u32 v8, v9
 s_mov_b64 exec, -1
 v_lshlrev_b32 v7, 4, v1
 buffer_store_dwordx4 v[16:19], v7, s[12:15], s36 offen offset:0 sc1
 buffer_store_dwordx4 v[20:23], v7, s[12:15], s36 offen offset:1024 sc1
 s_mov_b32 s43, 0x40000
 v_mov_b32 v8, 0
L_nl15:
 v_readfirstlane_b32 s60, v255
 s_cmp_lg_u32 s60, 0
 s_cbranch_scc1 L_nd15
 s_sub_u32 s43, s43, 1
 s_cbranch_scc1 L_nd15
 buffer_load_dword v255, v8, s[56:59], 0 offen offset:0 sc1
 s_waitcnt vmcnt(0)
 s_branch L_nl15
L_nd15:
 s_waitcnt vmcnt(0)
 s_mov_b64 exec, 1
 v_mov_b32 v8, 0
 v_mov_b32 v9, s60
 buffer_store_dword v9, v8, s[12:15], s37 offen offset:0 sc1
 s_mov_b64 exec, -1
 v_mov_b32 v8, 162868
 s_mov_b32 s43, 0x400000
L_ll16:
 ds_read_b32 v9, v8
 s_waitcnt lgkmcnt(0)
 v_cmp_gt_u32 vcc, 8, v9
 s_sub_u32 s43, s43, 1
 s_cbranch_scc1 L_ld16
 s_cbranch_vccz L_ld16
 s_sleep 1
 s_branch L_ll16
L_ld16:
L_gp_done:
 s_load_dwordx2 s[24:25], s[0:1], 32
 s_load_dwordx2 s[28:29], s[0:1], 72
 s_load_dwordx2 s[32:33], s[0:1], 88
 s_mov_b32 s26, 401408
 s_mov_b32 s27, 0x20000
 s_mov_b32 s30, 4096
 s_mov_b32 s31, 0x20000
 s_mov_b32 s34, 1835008
 s_mov_b32 s35, 0x20000
 s_waitcnt lgkmcnt(0)
 v_mov_b32 v8, 162848
 s_mov_b32 s43, 0x400000
L_ll17:
 ds_read_b32 v9, v8
 s_waitcnt lgkmcnt(0)
 v_cmp_gt_u32 vcc, 4, v9
 s_sub_u32 s43, s43, 1
 s_cbranch_scc1 L_ld17
 s_cbranch_vccz L_ld17
 s_sleep 1
 s_branch L_ll17
L_ld17:
 s_cmp_eq_u32 s46, 0
 s_cbranch_scc1 L_pref
 s_cmp_eq_u32 s46, 0
 s_cbranch_scc1 L_nofill
 v_lshrrev_b32 v7, 3, v1
 v_and_b32 v8, 7, v1
 v_lshrrev_b32 v9, 2, v1
 v_and_b32 v9, 4, v9
 v_xor_b32 v8, v8, v9
 v_mul_u32_u24 v7, 3584, v7
 v_lshl_add_u32 v10, v8, 4, v7
 v_add_u32 v11, 27648, v10
 s_add_u32 m0, s40, 0
 s_nop 0
 buffer_load_dwordx4 v10, s[8:11], s38 offen offset:0  lds
 buffer_load_dwordx4 v11, s[8:11], s38 offen offset:1024  lds
 s_add_u32 s38, s38, 57344
 s_add_u32 m0, s40, 2048
 s_nop 0
 buffer_load_dwordx4 v10, s[8:11], s38 offen offset:0  lds
 buffer_load_dwordx4 v11, s[8:11], s38 offen offset:1024  lds
 s_add_u32 s38, s38, 57344
 s_add_u32 m0, s40, 4096
 s_nop 0
 buffer_load_dwordx4 v10, s[8:11], s38 offen offset:0  lds
 buffer_load_dwordx4 v11, s[8:11], s38 offen offset:1024  lds
 s_add_u32 s38, s38, 57344
 s_add_u32 m0, s40, 6144
 s_nop 0
 buffer_load_dwordx4 v10, s[8:11], s38 offen offset:0  lds
 buffer_load_dwordx4 v11, s[8:11], s38 offen offset:1024  lds
 s_add_u32 s38, s38, 57344
 s_add_u32 m0, s40, 8192
 s_nop 0
 buffer_load_dwordx4 v10, s[8:11], s38 offen offset:0  lds
 buffer_load_dwordx4 v11, s[8:11], s38 offen offset:1024  lds
 s_add_u32 s38, s38, 57344
 v_lshlrev_b32 v7, 3, v2
 buffer_load_dwordx2 v[18:19], v7, s[16:19], s52 offen offset:0
 buffer_load_dwordx2 v[20:21], v7, s[16:19], s52 offen offset:16
 buffer_load_dwordx2 v[22:23], v7, s[16:19], s52 offen offset:32
 buffer_load_dwordx2 v[24:25], v7, s[16:19], s52 offen offset:48
L_nofill:
 v_lshlrev_b32 v7, 4, v1
 v_lshl_add_u32 v12, s7, 10, v7
 v_xor_b32 v13, 1024, v12
 v_mad_u32_u24 v7, v2, 8, v4
 v_lshl_add_u32 v7, v7, 7, v5
 v_lshrrev_b32 v8, 1, v4
 v_xor_b32 v8, s6, v8
 v_lshl_add_u32 v7, v8, 6, v7
 v_xor_b32 v8, 64, v7
 v_add_u32 v14, s40, v7
 v_add_u32 v15, s40, v8
 v_add_u32 v16, s48, v7
 v_add_u32 v17, s48, v8
 v_lshlrev_b32 v32, 7, v3
 s_mov_b32 s43, 0x40000
L_pl18:
 buffer_load_dword v9, v32, s[12:15], s53 offen offset:0 sc1
 s_waitcnt vmcnt(0)
 v_cmp_ne_u32 vcc, s60, v9
 s_sub_u32 s43, s43, 1
 s_cbranch_scc1 L_pd18
 s_cbranch_vccz L_pd18
 s_mov_b64 exec, vcc
 s_sleep 2
 s_branch L_pl18
L_pd18:
 s_mov_b64 exec, -1
 buffer_load_dwordx4 v[184:187], v12, s[12:15], s39 offen offset:0 sc1
 buffer_load_dwordx4 v[188:191], v13, s[12:15], s39 offen offset:0 sc1
 s_add_u32 s39, s39, 2048
 buffer_load_dwordx4 v[192:195], v12, s[12:15], s39 offen offset:0 sc1
 buffer_load_dwordx4 v[196:199], v13, s[12:15], s39 offen offset:0 sc1
 s_add_u32 s39, s39, 2048
 buffer_load_dwordx4 v[200:203], v12, s[12:15], s39 offen offset:0 sc1
 buffer_load_dwordx4 v[204:207], v13, s[12:15], s39 offen offset:0 sc1
 s_add_u32 s39, s39, 2048
 buffer_load_dwordx4 v[208:211], v12, s[12:15], s39 offen offset:0 sc1
 buffer_load_dwordx4 v[212:215], v13, s[12:15], s39 offen offset:0 sc1
 s_add_u32 s39, s39, 2048
 v_mov_b32 v8, 162856
 s_mov_b32 s43, 0x400000
L_ll19:
 ds_read_b32 v9, v8
 s_waitcnt lgkmcnt(0)
 v_cmp_gt_u32 vcc, 4, v9
 s_sub_u32 s43, s43, 1
 s_cbranch_scc1 L_ld19
 s_cbranch_vccz L_ld19
 s_sleep 1
 s_branch L_ll19
L_ld19:
 s_setprio 1
 ds_read_b64_tr_b16 v[168:169], v14 offset:0
 ds_read_b64_tr_b16 v[170:171], v14 offset:512
 ds_read_b64_tr_b16 v[172:173], v15 offset:0
 ds_read_b64_tr_b16 v[174:175], v15 offset:512
 s_waitcnt vmcnt(6)
 ds_read_b64_tr_b16 v[176:177], v14 offset:2048
 ds_read_b64_tr_b16 v[178:179], v14 offset:2560
 ds_read_b64_tr_b16 v[180:181], v15 offset:2048
 ds_read_b64_tr_b16 v[182:183], v15 offset:2560
 s_waitcnt lgkmcnt(4)
 v_mfma_f32_32x32x16_bf16 v[40:55], v[168:171], v[184:187], 0
 buffer_load_dwordx4 v[216:219], v12, s[12:15], s39 offen offset:0 sc1
 v_mfma_f32_32x32x16_bf16 v[56:71], v[168:171], v[188:191], 0
 buffer_load_dwordx4 v[220:223], v13, s[12:15], s39 offen offset:0 sc1
 v_mfma_f32_32x32x16_bf16 v[72:87], v[172:175], v[184:187], 0
 s_add_u32 s39, s39, 2048
 s_add_u32 m0, s48, 0
 s_nop 0
 buffer_load_dwordx4 v10, s[8:11], s38 offen offset:0  lds
 v_mfma_f32_32x32x16_bf16 v[88:103], v[172:175], v[188:191], 0
 buffer_load_dwordx4 v11, s[8:11], s38 offen offset:1024  lds
 s_add_u32 s38, s38, 57344
 s_waitcnt vmcnt(8)
 ds_read_b64_tr_b16 v[168:169], v14 offset:4096
 ds_read_b64_tr_b16 v[170:171], v14 offset:4608
 ds_read_b64_tr_b16 v[172:173], v15 offset:4096
 ds_read_b64_tr_b16 v[174:175], v15 offset:4608
 s_waitcnt lgkmcnt(4)
 v_mfma_f32_32x32x16_bf16 v[40:55], v[176:179], v[192:195], v[40:55]
 buffer_load_dwordx4 v[224:227], v12, s[12:15], s39 offen offset:0 sc1
 v_mfma_f32_32x32x16_bf16 v[56:71], v[176:179], v[196:199], v[56:71]
 buffer_load_dwordx4 v[228:231], v13, s[12:15], s39 offen offset:0 sc1
 v_mfma_f32_32x32x16_bf16 v[72:87], v[180:183], v[192:195], v[72:87]
 s_add_u32 s39, s39, 2048
 s_add_u32 m0, s48, 2048
 s_nop 0
 buffer_load_dwordx4 v10, s[8:11], s38 offen offset:0  lds
 v_mfma_f32_32x32x16_bf16 v[88:103], v[180:183], v[196:199], v[88:103]
 buffer_load_dwordx4 v11, s[8:11], s38 offen offset:1024  lds
 s_add_u32 s38, s38, 57344
 s_waitcnt vmcnt(10)
 ds_read_b64_tr_b16 v[176:177], v14 offset:6144
 ds_read_b64_tr_b16 v[178:179], v14 offset:6656
 ds_read_b64_tr_b16 v[180:181], v15 offset:6144
 ds_read_b64_tr_b16 v[182:183], v15 offset:6656
 s_waitcnt lgkmcnt(4)
 v_mfma_f32_32x32x16_bf16 v[40:55], v[168:171], v[200:203], v[40:55]
 buffer_load_dwordx4 v[232:235], v12, s[12:15], s39 offen offset:0 sc1
 v_mfma_f32_32x32x16_bf16 v[56:71], v[168:171], v[204:207], v[56:71]
 buffer_load_dwordx4 v[236:239], v13, s[12:15], s39 offen offset:0 sc1
 v_mfma_f32_32x32x16_bf16 v[72:87], v[172:175], v[200:203], v[72:87]
 s_add_u32 s39, s39, 2048
 s_add_u32 m0, s48, 4096
 s_nop 0
 buffer_load_dwordx4 v10, s[8:11], s38 offen offset:0  lds
 v_mfma_f32_32x32x16_bf16 v[88:103], v[172:175], v[204:207], v[88:103]
 buffer_load_dwordx4 v11, s[8:11], s38 offen offset:1024  lds
 s_add_u32 s38, s38, 57344
 s_cmp_eq_u32 s47, 1
 s_cselect_b32 s42, 1835008, 0
 s_sub_u32 s38, s38, s42
 s_waitcnt vmcnt(12)
 ds_read_b64_tr_b16 v[168:169], v14 offset:8192
 ds_read_b64_tr_b16 v[170:171], v14 offset:8704
 ds_read_b64_tr_b16 v[172:173], v15 offset:8192
 ds_read_b64_tr_b16 v[174:175], v15 offset:8704
 s_waitcnt lgkmcnt(4)
 v_mfma_f32_32x32x16_bf16 v[40:55], v[176:179], v[208:211], v[40:55]
 buffer_load_dwordx4 v[240:243], v12, s[12:15], s39 offen offset:0 sc1
 v_mfma_f32_32x32x16_bf16 v[56:71], v[176:179], v[212:215], v[56:71]
 buffer_load_dwordx4 v[244:247], v13, s[12:15], s39 offen offset:0 sc1
 v_mfma_f32_32x32x16_bf16 v[72:87], v[180:183], v[208:211], v[72:87]
 s_add_u32 s39, s39, 2048
 s_cmp_eq_u32 s47, 1
 s_cselect_b32 s42, 65536, 0
 s_sub_u32 s39, s39, s42
 s_add_u32 m0, s48, 6144
 s_nop 0
 buffer_load_dwordx4 v10, s[8:11], s38 offen offset:0  lds
 v_mfma_f32_32x32x16_bf16 v[88:103], v[180:183], v[212:215], v[88:103]
 buffer_load_dwordx4 v11, s[8:11], s38 offen offset:1024  lds
 s_add_u32 s38, s38, 57344
 s_waitcnt vmcnt(12)
 ds_read_b64_tr_b16 v[176:177], v16 offset:0
 ds_read_b64_tr_b16 v[178:179], v16 offset:512
 ds_read_b64_tr_b16 v[180:181], v17 offset:0
 ds_read_b64_tr_b16 v[182:183], v17 offset:512
 s_waitcnt lgkmcnt(4)
 v_mfma_f32_32x32x16_bf16 v[40:55], v[168:171], v[216:219], v[40:55]
 buffer_load_dwordx4 v[184:187], v12, s[12:15], s39 offen offset:0 sc1
 v_mfma_f32_32x32x16_bf16 v[56:71], v[168:171], v[220:223], v[56:71]
 buffer_load_dwordx4 v[188:191], v13, s[12:15], s39 offen offset:0 sc1
 v_mfma_f32_32x32x16_bf16 v[72:87], v[172:175], v[216:219], v[72:87]
 s_add_u32 s39, s39, 2048
 s_add_u32 m0, s48, 8192
 s_nop 0
 buffer_load_dwordx4 v10, s[8:11], s38 offen offset:0  lds
 v_mfma_f32_32x32x16_bf16 v[88:103], v[172:175], v[220:223], v[88:103]
 buffer_load_dwordx4 v11, s[8:11], s38 offen offset:1024  lds
 s_add_u32 s38, s38, 57344
 s_waitcnt vmcnt(12)
 ds_read_b64_tr_b16 v[168:169], v16 offset:2048
 ds_read_b64_tr_b16 v[170:171], v16 offset:2560
 ds_read_b64_tr_b16 v[172:173], v17 offset:2048
 ds_read_b64_tr_b16 v[174:175], v17 offset:2560
 s_waitcnt lgkmcnt(4)
 v_mfma_f32_32x32x16_bf16 v[40:55], v[176:179], v[224:227], v[40:55]
 buffer_load_dwordx4 v[192:195], v12, s[12:15], s39 offen offset:0 sc1
 v_mfma_f32_32x32x16_bf16 v[56:71], v[176:179], v[228:231], v[56:71]
 buffer_load_dwordx4 v[196:199], v13, s[12:15], s39 offen offset:0 sc1
 v_mfma_f32_32x32x16_bf16 v[72:87], v[180:183], v[224:227], v[72:87]
 s_add_u32 s39, s39, 2048
 s_add_u32 m0, s48, 10240
 s_nop 0
 buffer_load_dwordx4 v10, s[8:11], s38 offen offset:0  lds
 v_mfma_f32_32x32x16_bf16 v[88:103], v[180:183], v[228:231], v[88:103]
 buffer_load_dwordx4 v11, s[8:11], s38 offen offset:1024  lds
 s_add_u32 s38, s38, 57344
 s_waitcnt vmcnt(12)
 ds_read_b64_tr_b16 v[176:177], v16 offset:4096
 ds_read_b64_tr_b16 v[178:179], v16 offset:4608
 ds_read_b64_tr_b16 v[180:181], v17 offset:4096
 ds_read_b64_tr_b16 v[182:183], v17 offset:4608
 s_waitcnt lgkmcnt(4)
 v_mfma_f32_32x32x16_bf16 v[40:55], v[168:171], v[232:235], v[40:55]
 buffer_load_dwordx4 v[200:203], v12, s[12:15], s39 offen offset:0 sc1
 v_mfma_f32_32x32x16_bf16 v[56:71], v[168:171], v[236:239], v[56:71]
 buffer_load_dwordx4 v[204:207], v13, s[12:15], s39 offen offset:0 sc1
 v_mfma_f32_32x32x16_bf16 v[72:87], v[172:175], v[232:235], v[72:87]
 s_add_u32 s39, s39, 2048
 s_add_u32 m0, s48, 12288
 s_nop 0
 buffer_load_dwordx4 v10, s[8:11], s38 offen offset:0  lds
 v_mfma_f32_32x32x16_bf16 v[88:103], v[172:175], v[236:239], v[88:103]
 buffer_load_dwordx4 v11, s[8:11], s38 offen offset:1024  lds
 s_add_u32 s38, s38, 57344
 s_waitcnt vmcnt(12)
 ds_read_b64_tr_b16 v[168:169], v16 offset:6144
 ds_read_b64_tr_b16 v[170:171], v16 offset:6656
 ds_read_b64_tr_b16 v[172:173], v17 offset:6144
 ds_read_b64_tr_b16 v[174:175], v17 offset:6656
 s_waitcnt lgkmcnt(4)
 v_mfma_f32_32x32x16_bf16 v[40:55], v[176:179], v[240:243], v[40:55]
 buffer_load_dwordx4 v[208:211], v12, s[12:15], s39 offen offset:0 sc1
 v_mfma_f32_32x32x16_bf16 v[56:71], v[176:179], v[244:247], v[56:71]
 buffer_load_dwordx4 v[212:215], v13, s[12:15], s39 offen offset:0 sc1
 v_mfma_f32_32x32x16_bf16 v[72:87], v[180:183], v[240:243], v[72:87]
 s_add_u32 s39, s39, 2048
 s_add_u32 m0, s40, 0
 s_nop 0
 buffer_load_dwordx4 v10, s[8:11], s38 offen offset:0  lds
 v_mfma_f32_32x32x16_bf16 v[88:103], v[180:183], v[244:247], v[88:103]
 buffer_load_dwordx4 v11, s[8:11], s38 offen offset:1024  lds
 s_add_u32 s38, s38, 57344
 s_waitcnt vmcnt(12)
 ds_read_b64_tr_b16 v[176:177], v16 offset:8192
 ds_read_b64_tr_b16 v[178:179], v16 offset:8704
 ds_read_b64_tr_b16 v[180:181], v17 offset:8192
 ds_read_b64_tr_b16 v[182:183], v17 offset:8704
 s_waitcnt lgkmcnt(4)
 v_mfma_f32_32x32x16_bf16 v[40:55], v[168:171], v[184:187], v[40:55]
 buffer_load_dwordx4 v[216:219], v12, s[12:15], s39 offen offset:0 sc1
 v_mfma_f32_32x32x16_bf16 v[56:71], v[168:171], v[188:191], v[56:71]
 buffer_load_dwordx4 v[220:223], v13, s[12:15], s39 offen offset:0 sc1
 v_mfma_f32_32x32x16_bf16 v[72:87], v[172:175], v[184:187], v[72:87]
 s_add_u32 s39, s39, 2048
 s_add_u32 m0, s40, 2048
 s_nop 0
 buffer_load_dwordx4 v10, s[8:11], s38 offen offset:0  lds
 v_mfma_f32_32x32x16_bf16 v[88:103], v[172:175], v[188:191], v[88:103]
 buffer_load_dwordx4 v11, s[8:11], s38 offen offset:1024  lds
 s_add_u32 s38, s38, 57344
 s_waitcnt vmcnt(12)
 ds_read_b64_tr_b16 v[168:169], v16 offset:10240
 ds_read_b64_tr_b16 v[170:171], v16 offset:10752
 ds_read_b64_tr_b16 v[172:173], v17 offset:10240
 ds_read_b64_tr_b16 v[174:175], v17 offset:10752
 s_waitcnt lgkmcnt(4)
 v_mfma_f32_32x32x16_bf16 v[40:55], v[176:179], v[192:195], v[40:55]
 buffer_load_dwordx4 v[224:227], v12, s[12:15], s39 offen offset:0 sc1
 v_mfma_f32_32x32x16_bf16 v[56:71], v[176:179], v[196:199], v[56:71]
 buffer_load_dwordx4 v[228:231], v13, s[12:15], s39 offen offset:0 sc1
 v_mfma_f32_32x32x16_bf16 v[72:87], v[180:183], v[192:195], v[72:87]
 s_add_u32 s39, s39, 2048
 s_add_u32 m0, s40, 4096
 s_nop 0
 buffer_load_dwordx4 v10, s[8:11], s38 offen offset:0  lds
 v_mfma_f32_32x32x16_bf16 v[88:103], v[180:183], v[196:199], v[88:103]
 buffer_load_dwordx4 v11, s[8:11], s38 offen offset:1024  lds
 s_add_u32 s38, s38, 57344
 s_waitcnt vmcnt(12)
 ds_read_b64_tr_b16 v[176:177], v16 offset:12288
 ds_read_b64_tr_b16 v[178:179], v16 offset:12800
 ds_read_b64_tr_b16 v[180:181], v17 offset:12288
 ds_read_b64_tr_b16 v[182:183], v17 offset:12800
 s_waitcnt lgkmcnt(4)
 v_mfma_f32_32x32x16_bf16 v[40:55], v[168:171], v[200:203], v[40:55]
 buffer_load_dwordx4 v[232:235], v12, s[12:15], s39 offen offset:0 sc1
 v_mfma_f32_32x32x16_bf16 v[56:71], v[168:171], v[204:207], v[56:71]
 buffer_load_dwordx4 v[236:239], v13, s[12:15], s39 offen offset:0 sc1
 v_mfma_f32_32x32x16_bf16 v[72:87], v[172:175], v[200:203], v[72:87]
 s_add_u32 s39, s39, 2048
 s_add_u32 m0, s40, 6144
 s_nop 0
 buffer_load_dwordx4 v10, s[8:11], s38 offen offset:0  lds
 v_mfma_f32_32x32x16_bf16 v[88:103], v[172:175], v[204:207], v[88:103]
 buffer_load_dwordx4 v11, s[8:11], s38 offen offset:1024  lds
 s_add_u32 s38, s38, 57344
 s_cmp_eq_u32 s47, 2
 s_cselect_b32 s42, 1835008, 0
 s_sub_u32 s38, s38, s42
 s_waitcnt vmcnt(12)
 ds_read_b64_tr_b16 v[168:169], v14 offset:0
 ds_read_b64_tr_b16 v[170:171], v14 offset:512
 ds_read_b64_tr_b16 v[172:173], v15 offset:0
 ds_read_b64_tr_b16 v[174:175], v15 offset:512
 s_waitcnt lgkmcnt(4)
 v_mfma_f32_32x32x16_bf16 v[40:55], v[176:179], v[208:211], v[40:55]
 buffer_load_dwordx4 v[240:243], v12, s[12:15], s39 offen offset:0 sc1
 v_mfma_f32_32x32x16_bf16 v[56:71], v[176:179], v[212:215], v[56:71]
 buffer_load_dwordx4 v[244:247], v13, s[12:15], s39 offen offset:0 sc1
 v_mfma_f32_32x32x16_bf16 v[72:87], v[180:183], v[208:211], v[72:87]
 s_add_u32 s39, s39, 2048
 s_cmp_eq_u32 s47, 2
 s_cselect_b32 s42, 65536, 0
 s_sub_u32 s39, s39, s42
 s_add_u32 m0, s40, 8192
 s_nop 0
 buffer_load_dwordx4 v10, s[8:11], s38 offen offset:0  lds
 v_mfma_f32_32x32x16_bf16 v[88:103], v[180:183], v[212:215], v[88:103]
 buffer_load_dwordx4 v11, s[8:11], s38 offen offset:1024  lds
 s_add_u32 s38, s38, 57344
 s_waitcnt vmcnt(12)
 ds_read_b64_tr_b16 v[176:177], v14 offset:2048
 ds_read_b64_tr_b16 v[178:179], v14 offset:2560
 ds_read_b64_tr_b16 v[180:181], v15 offset:2048
 ds_read_b64_tr_b16 v[182:183], v15 offset:2560
 s_waitcnt lgkmcnt(4)
 v_mfma_f32_32x32x16_bf16 v[40:55], v[168:171], v[216:219], v[40:55]
 buffer_load_dwordx4 v[184:187], v12, s[12:15], s39 offen offset:0 sc1
 v_mfma_f32_32x32x16_bf16 v[56:71], v[168:171], v[220:223], v[56:71]
 buffer_load_dwordx4 v[188:191], v13, s[12:15], s39 offen offset:0 sc1
 v_mfma_f32_32x32x16_bf16 v[72:87], v[172:175], v[216:219], v[72:87]
 s_add_u32 s39, s39, 2048
 s_add_u32 m0, s48, 0
 s_nop 0
 buffer_load_dwordx4 v10, s[8:11], s38 offen offset:0  lds
 v_mfma_f32_32x32x16_bf16 v[88:103], v[172:175], v[220:223], v[88:103]
 buffer_load_dwordx4 v11, s[8:11], s38 offen offset:1024  lds
 s_add_u32 s38, s38, 57344
 s_waitcnt vmcnt(12)
 ds_read_b64_tr_b16 v[168:169], v14 offset:4096
 ds_read_b64_tr_b16 v[170:171], v14 offset:4608
 ds_read_b64_tr_b16 v[172:173], v15 offset:4096
 ds_read_b64_tr_b16 v[174:175], v15 offset:4608
 s_waitcnt lgkmcnt(4)
 v_mfma_f32_32x32x16_bf16 v[40:55], v[176:179], v[224:227], v[40:55]
 buffer_load_dwordx4 v[192:195], v12, s[12:15], s39 offen offset:0 sc1
 v_mfma_f32_32x32x16_bf16 v[56:71], v[176:179], v[228:231], v[56:71]
 buffer_load_dwordx4 v[196:199], v13, s[12:15], s39 offen offset:0 sc1
 v_mfma_f32_32x32x16_bf16 v[72:87], v[180:183], v[224:227], v[72:87]
 s_add_u32 s39, s39, 2048
 s_add_u32 m0, s48, 2048
 s_nop 0
 buffer_load_dwordx4 v10, s[8:11], s38 offen offset:0  lds
 v_mfma_f32_32x32x16_bf16 v[88:103], v[180:183], v[228:231], v[88:103]
 buffer_load_dwordx4 v11, s[8:11], s38 offen offset:1024  lds
 s_add_u32 s38, s38, 57344
 s_waitcnt vmcnt(12)
 ds_read_b64_tr_b16 v[176:177], v14 offset:6144
 ds_read_b64_tr_b16 v[178:179], v14 offset:6656
 ds_read_b64_tr_b16 v[180:181], v15 offset:6144
 ds_read_b64_tr_b16 v[182:183], v15 offset:6656
 s_waitcnt lgkmcnt(4)
 v_mfma_f32_32x32x16_bf16 v[40:55], v[168:171], v[232:235], v[40:55]
 buffer_load_dwordx4 v[200:203], v12, s[12:15], s39 offen offset:0 sc1
 v_mfma_f32_32x32x16_bf16 v[56:71], v[168:171], v[236:239], v[56:71]
 buffer_load_dwordx4 v[204:207], v13, s[12:15], s39 offen offset:0 sc1
 v_mfma_f32_32x32x16_bf16 v[72:87], v[172:175], v[232:235], v[72:87]
 s_add_u32 s39, s39, 2048
 s_add_u32 m0, s48, 4096
 s_nop 0
 buffer_load_dwordx4 v10, s[8:11], s38 offen offset:0  lds
 v_mfma_f32_32x32x16_bf16 v[88:103], v[172:175], v[236:239], v[88:103]
 buffer_load_dwordx4 v11, s[8:11], s38 offen offset:1024  lds
 s_add_u32 s38, s38, 57344
 s_waitcnt vmcnt(12)
 ds_read_b64_tr_b16 v[168:169], v14 offset:8192
 ds_read_b64_tr_b16 v[170:171], v14 offset:8704
 ds_read_b64_tr_b16 v[172:173], v15 offset:8192
 ds_read_b64_tr_b16 v[174:175], v15 offset:8704
 s_waitcnt lgkmcnt(4)
 v_mfma_f32_32x32x16_bf16 v[40:55], v[176:179], v[240:243], v[40:55]
 buffer_load_dwordx4 v[208:211], v12, s[12:15], s39 offen offset:0 sc1
 v_mfma_f32_32x32x16_bf16 v[56:71], v[176:179], v[244:247], v[56:71]
 buffer_load_dwordx4 v[212:215], v13, s[12:15], s39 offen offset:0 sc1
 v_mfma_f32_32x32x16_bf16 v[72:87], v[180:183], v[240:243], v[72:87]
 s_add_u32 s39, s39, 2048
 s_add_u32 m0, s48, 6144
 s_nop 0
 buffer_load_dwordx4 v10, s[8:11], s38 offen offset:0  lds
 v_mfma_f32_32x32x16_bf16 v[88:103], v[180:183], v[244:247], v[88:103]
 buffer_load_dwordx4 v11, s[8:11], s38 offen offset:1024  lds
 s_add_u32 s38, s38, 57344
 s_waitcnt vmcnt(12)
 ds_read_b64_tr_b16 v[176:177], v16 offset:0
 ds_read_b64_tr_b16 v[178:179], v16 offset:512
 ds_read_b64_tr_b16 v[180:181], v17 offset:0
 ds_read_b64_tr_b16 v[182:183], v17 offset:512
 s_waitcnt lgkmcnt(4)
 v_mfma_f32_32x32x16_bf16 v[40:55], v[168:171], v[184:187], v[40:55]
 buffer_load_dwordx4 v[216:219], v12, s[12:15], s39 offen offset:0 sc1
 v_mfma_f32_32x32x16_bf16 v[56:71], v[168:171], v[188:191], v[56:71]
 buffer_load_dwordx4 v[220:223], v13, s[12:15], s39 offen offset:0 sc1
 v_mfma_f32_32x32x16_bf16 v[72:87], v[172:175], v[184:187], v[72:87]
 s_add_u32 s39, s39, 2048
 s_add_u32 m0, s48, 8192
 s_nop 0
 buffer_load_dwordx4 v10, s[8:11], s38 offen offset:0  lds
 v_mfma_f32_32x32x16_bf16 v[88:103], v[172:175], v[188:191], v[88:103]
 buffer_load_dwordx4 v11, s[8:11], s38 offen offset:1024  lds
 s_add_u32 s38, s38, 57344
 s_waitcnt vmcnt(12)
 ds_read_b64_tr_b16 v[168:169], v16 offset:2048
 ds_read_b64_tr_b16 v[170:171], v16 offset:2560
 ds_read_b64_tr_b16 v[172:173], v17 offset:2048
 ds_read_b64_tr_b16 v[174:175], v17 offset:2560
 s_waitcnt lgkmcnt(4)
 v_mfma_f32_32x32x16_bf16 v[40:55], v[176:179], v[192:195], v[40:55]
 buffer_load_dwordx4 v[224:227], v12, s[12:15], s39 offen offset:0 sc1
 v_mfma_f32_32x32x16_bf16 v[56:71], v[176:179], v[196:199], v[56:71]
 buffer_load_dwordx4 v[228:231], v13, s[12:15], s39 offen offset:0 sc1
 v_mfma_f32_32x32x16_bf16 v[72:87], v[180:183], v[192:195], v[72:87]
 s_add_u32 s39, s39, 2048
 s_add_u32 m0, s48, 10240
 s_nop 0
 buffer_load_dwordx4 v10, s[8:11], s38 offen offset:0  lds
 v_mfma_f32_32x32x16_bf16 v[88:103], v[180:183], v[196:199], v[88:103]
 buffer_load_dwordx4 v11, s[8:11], s38 offen offset:1024  lds
 s_add_u32 s38, s38, 57344
 s_waitcnt vmcnt(12)
 ds_read_b64_tr_b16 v[176:177], v16 offset:4096
 ds_read_b64_tr_b16 v[178:179], v16 offset:4608
 ds_read_b64_tr_b16 v[180:181], v17 offset:4096
 ds_read_b64_tr_b16 v[182:183], v17 offset:4608
 s_waitcnt lgkmcnt(4)
 v_mfma_f32_32x32x16_bf16 v[40:55], v[168:171], v[200:203], v[40:55]
 buffer_load_dwordx4 v[232:235], v12, s[12:15], s39 offen offset:0 sc1
 v_mfma_f32_32x32x16_bf16 v[56:71], v[168:171], v[204:207], v[56:71]
 buffer_load_dwordx4 v[236:239], v13, s[12:15], s39 offen offset:0 sc1
 v_mfma_f32_32x32x16_bf16 v[72:87], v[172:175], v[200:203], v[72:87]
 s_add_u32 s39, s39, 2048
 s_add_u32 m0, s48, 12288
 s_nop 0
 buffer_load_dwordx4 v10, s[8:11], s38 offen offset:0  lds
 v_mfma_f32_32x32x16_bf16 v[88:103], v[172:175], v[204:207], v[88:103]
 buffer_load_dwordx4 v11, s[8:11], s38 offen offset:1024  lds
 s_add_u32 s38, s38, 57344
 s_cmp_eq_u32 s47, 3
 s_cselect_b32 s42, 1835008, 0
 s_sub_u32 s38, s38, s42
 s_waitcnt vmcnt(12)
 ds_read_b64_tr_b16 v[168:169], v16 offset:6144
 ds_read_b64_tr_b16 v[170:171], v16 offset:6656
 ds_read_b64_tr_b16 v[172:173], v17 offset:6144
 ds_read_b64_tr_b16 v[174:175], v17 offset:6656
 s_waitcnt lgkmcnt(4)
 v_mfma_f32_32x32x16_bf16 v[40:55], v[176:179], v[208:211], v[40:55]
 buffer_load_dwordx4 v[240:243], v12, s[12:15], s39 offen offset:0 sc1
 v_mfma_f32_32x32x16_bf16 v[56:71], v[176:179], v[212:215], v[56:71]
 buffer_load_dwordx4 v[244:247], v13, s[12:15], s39 offen offset:0 sc1
 v_mfma_f32_32x32x16_bf16 v[72:87], v[180:183], v[208:211], v[72:87]
 s_add_u32 s39, s39, 2048
 s_cmp_eq_u32 s47, 3
 s_cselect_b32 s42, 65536, 0
 s_sub_u32 s39, s39, s42
 s_add_u32 m0, s40, 0
 s_nop 0
 buffer_load_dwordx4 v10, s[8:11], s38 offen offset:0  lds
 v_mfma_f32_32x32x16_bf16 v[88:103], v[180:183], v[212:215], v[88:103]
 buffer_load_dwordx4 v11, s[8:11], s38 offen offset:1024  lds
 s_add_u32 s38, s38, 57344
 s_waitcnt vmcnt(12)
 ds_read_b64_tr_b16 v[176:177], v16 offset:8192
 ds_read_b64_tr_b16 v[178:179], v16 offset:8704
 ds_read_b64_tr_b16 v[180:181], v17 offset:8192
 ds_read_b64_tr_b16 v[182:183], v17 offset:8704
 s_waitcnt lgkmcnt(4)
 v_mfma_f32_32x32x16_bf16 v[40:55], v[168:171], v[216:219], v[40:55]
 buffer_load_dwordx4 v[184:187], v12, s[12:15], s39 offen offset:0 sc1
 v_mfma_f32_32x32x16_bf16 v[56:71], v[168:171], v[220:223], v[56:71]
 buffer_load_dwordx4 v[188:191], v13, s[12:15], s39 offen offset:0 sc1
 v_mfma_f32_32x32x16_bf16 v[72:87], v[172:175], v[216:219], v[72:87]
 s_add_u32 s39, s39, 2048
 s_add_u32 m0, s40, 2048
 s_nop 0
 buffer_load_dwordx4 v10, s[8:11], s38 offen offset:0  lds
 v_mfma_f32_32x32x16_bf16 v[88:103], v[172:175], v[220:223], v[88:103]
 buffer_load_dwordx4 v11, s[8:11], s38 offen offset:1024  lds
 s_add_u32 s38, s38, 57344
 s_waitcnt vmcnt(12)
 ds_read_b64_tr_b16 v[168:169], v16 offset:10240
 ds_read_b64_tr_b16 v[170:171], v16 offset:10752
 ds_read_b64_tr_b16 v[172:173], v17 offset:10240
 ds_read_b64_tr_b16 v[174:175], v17 offset:10752
 s_waitcnt lgkmcnt(4)
 v_mfma_f32_32x32x16_bf16 v[40:55], v[176:179], v[224:227], v[40:55]
 buffer_load_dwordx4 v[192:195], v12, s[12:15], s39 offen offset:0 sc1
 v_mfma_f32_32x32x16_bf16 v[56:71], v[176:179], v[228:231], v[56:71]
 buffer_load_dwordx4 v[196:199], v13, s[12:15], s39 offen offset:0 sc1
 v_mfma_f32_32x32x16_bf16 v[72:87], v[180:183], v[224:227], v[72:87]
 s_add_u32 s39, s39, 2048
 s_add_u32 m0, s40, 4096
 s_nop 0
 buffer_load_dwordx4 v10, s[8:11], s38 offen offset:0  lds
 v_mfma_f32_32x32x16_bf16 v[88:103], v[180:183], v[228:231], v[88:103]
 buffer_load_dwordx4 v11, s[8:11], s38 offen offset:1024  lds
 s_add_u32 s38, s38, 57344
 s_waitcnt vmcnt(12)
 ds_read_b64_tr_b16 v[176:177], v16 offset:12288
 ds_read_b64_tr_b16 v[178:179], v16 offset:12800
 ds_read_b64_tr_b16 v[180:181], v17 offset:12288
 ds_read_b64_tr_b16 v[182:183], v17 offset:12800
 s_waitcnt lgkmcnt(4)
 v_mfma_f32_32x32x16_bf16 v[40:55], v[168:171], v[232:235], v[40:55]
 buffer_load_dwordx4 v[200:203], v12, s[12:15], s39 offen offset:0 sc1
 v_mfma_f32_32x32x16_bf16 v[56:71], v[168:171], v[236:239], v[56:71]
 buffer_load_dwordx4 v[204:207], v13, s[12:15], s39 offen offset:0 sc1
 v_mfma_f32_32x32x16_bf16 v[72:87], v[172:175], v[232:235], v[72:87]
 s_add_u32 s39, s39, 2048
 s_add_u32 m0, s40, 6144
 s_nop 0
 buffer_load_dwordx4 v10, s[8:11], s38 offen offset:0  lds
 v_mfma_f32_32x32x16_bf16 v[88:103], v[172:175], v[236:239], v[88:103]
 buffer_load_dwordx4 v11, s[8:11], s38 offen offset:1024  lds
 s_add_u32 s38, s38, 57344
 s_waitcnt vmcnt(12)
 ds_read_b64_tr_b16 v[168:169], v14 offset:0
 ds_read_b64_tr_b16 v[170:171], v14 offset:512
 ds_read_b64_tr_b16 v[172:173], v15 offset:0
 ds_read_b64_tr_b16 v[174:175], v15 offset:512
 s_waitcnt lgkmcnt(4)
 v_mfma_f32_32x32x16_bf16 v[40:55], v[176:179], v[240:243], v[40:55]
 buffer_load_dwordx4 v[208:211], v12, s[12:15], s39 offen offset:0 sc1
 v_mfma_f32_32x32x16_bf16 v[56:71], v[176:179], v[244:247], v[56:71]
 buffer_load_dwordx4 v[212:215], v13, s[12:15], s39 offen offset:0 sc1
 v_mfma_f32_32x32x16_bf16 v[72:87], v[180:183], v[240:243], v[72:87]
 s_add_u32 s39, s39, 2048
 s_add_u32 m0, s40, 8192
 s_nop 0
 buffer_load_dwordx4 v10, s[8:11], s38 offen offset:0  lds
 v_mfma_f32_32x32x16_bf16 v[88:103], v[180:183], v[244:247], v[88:103]
 buffer_load_dwordx4 v11, s[8:11], s38 offen offset:1024  lds
 s_add_u32 s38, s38, 57344
 s_waitcnt vmcnt(12)
 ds_read_b64_tr_b16 v[176:177], v14 offset:2048
 ds_read_b64_tr_b16 v[178:179], v14 offset:2560
 ds_read_b64_tr_b16 v[180:181], v15 offset:2048
 ds_read_b64_tr_b16 v[182:183], v15 offset:2560
 s_waitcnt lgkmcnt(4)
 v_mfma_f32_32x32x16_bf16 v[40:55], v[168:171], v[184:187], v[40:55]
 buffer_load_dwordx4 v[216:219], v12, s[12:15], s39 offen offset:0 sc1
 v_mfma_f32_32x32x16_bf16 v[56:71], v[168:171], v[188:191], v[56:71]
 buffer_load_dwordx4 v[220:223], v13, s[12:15], s39 offen offset:0 sc1
 v_mfma_f32_32x32x16_bf16 v[72:87], v[172:175], v[184:187], v[72:87]
 s_add_u32 s39, s39, 2048
 s_add_u32 m0, s48, 0
 s_nop 0
 buffer_load_dwordx4 v10, s[8:11], s38 offen offset:0  lds
 v_mfma_f32_32x32x16_bf16 v[88:103], v[172:175], v[188:191], v[88:103]
 buffer_load_dwordx4 v11, s[8:11], s38 offen offset:1024  lds
 s_add_u32 s38, s38, 57344
 s_waitcnt vmcnt(12)
 ds_read_b64_tr_b16 v[168:169], v14 offset:4096
 ds_read_b64_tr_b16 v[170:171], v14 offset:4608
 ds_read_b64_tr_b16 v[172:173], v15 offset:4096
 ds_read_b64_tr_b16 v[174:175], v15 offset:4608
 s_waitcnt lgkmcnt(4)
 v_mfma_f32_32x32x16_bf16 v[40:55], v[176:179], v[192:195], v[40:55]
 buffer_load_dwordx4 v[224:227], v12, s[12:15], s39 offen offset:0 sc1
 v_mfma_f32_32x32x16_bf16 v[56:71], v[176:179], v[196:199], v[56:71]
 buffer_load_dwordx4 v[228:231], v13, s[12:15], s39 offen offset:0 sc1
 v_mfma_f32_32x32x16_bf16 v[72:87], v[180:183], v[192:195], v[72:87]
 s_add_u32 s39, s39, 2048
 s_add_u32 m0, s48, 2048
 s_nop 0
 buffer_load_dwordx4 v10, s[8:11], s38 offen offset:0  lds
 v_mfma_f32_32x32x16_bf16 v[88:103], v[180:183], v[196:199], v[88:103]
 buffer_load_dwordx4 v11, s[8:11], s38 offen offset:1024  lds
 s_add_u32 s38, s38, 57344
 s_waitcnt vmcnt(12)
 ds_read_b64_tr_b16 v[176:177], v14 offset:6144
 ds_read_b64_tr_b16 v[178:179], v14 offset:6656
 ds_read_b64_tr_b16 v[180:181], v15 offset:6144
 ds_read_b64_tr_b16 v[182:183], v15 offset:6656
 s_waitcnt lgkmcnt(4)
 v_mfma_f32_32x32x16_bf16 v[40:55], v[168:171], v[200:203], v[40:55]
 buffer_load_dwordx4 v[232:235], v12, s[12:15], s39 offen offset:0 sc1
 v_mfma_f32_32x32x16_bf16 v[56:71], v[168:171], v[204:207], v[56:71]
 buffer_load_dwordx4 v[236:239], v13, s[12:15], s39 offen offset:0 sc1
 v_mfma_f32_32x32x16_bf16 v[72:87], v[172:175], v[200:203], v[72:87]
 s_add_u32 s39, s39, 2048
 s_add_u32 m0, s48, 4096
 s_nop 0
 buffer_load_dwordx4 v10, s[8:11], s38 offen offset:0  lds
 v_mfma_f32_32x32x16_bf16 v[88:103], v[172:175], v[204:207], v[88:103]
 buffer_load_dwordx4 v11, s[8:11], s38 offen offset:1024  lds
 s_add_u32 s38, s38, 57344
 s_waitcnt vmcnt(12)
 ds_read_b64_tr_b16 v[168:169], v14 offset:8192
 ds_read_b64_tr_b16 v[170:171], v14 offset:8704
 ds_read_b64_tr_b16 v[172:173], v15 offset:8192
 ds_read_b64_tr_b16 v[174:175], v15 offset:8704
 s_waitcnt lgkmcnt(4)
 v_mfma_f32_32x32x16_bf16 v[40:55], v[176:179], v[208:211], v[40:55]
 buffer_load_dwordx4 v[240:243], v12, s[12:15], s39 offen offset:0 sc1
 v_mfma_f32_32x32x16_bf16 v[56:71], v[176:179], v[212:215], v[56:71]
 buffer_load_dwordx4 v[244:247], v13, s[12:15], s39 offen offset:0 sc1
 v_mfma_f32_32x32x16_bf16 v[72:87], v[180:183], v[208:211], v[72:87]
 s_add_u32 s39, s39, 2048
 v_mfma_f32_32x32x16_bf16 v[88:103], v[180:183], v[212:215], v[88:103]
 s_waitcnt vmcnt(10)
 ds_read_b64_tr_b16 v[176:177], v16 offset:0
 ds_read_b64_tr_b16 v[178:179], v16 offset:512
 ds_read_b64_tr_b16 v[180:181], v17 offset:0
 ds_read_b64_tr_b16 v[182:183], v17 offset:512
 s_waitcnt lgkmcnt(4)
 v_mfma_f32_32x32x16_bf16 v[40:55], v[168:171], v[216:219], v[40:55]
 v_mfma_f32_32x32x16_bf16 v[56:71], v[168:171], v[220:223], v[56:71]
 v_mfma_f32_32x32x16_bf16 v[72:87], v[172:175], v[216:219], v[72:87]
 v_mfma_f32_32x32x16_bf16 v[88:103], v[172:175], v[220:223], v[88:103]
 s_waitcnt vmcnt(6)
 ds_read_b64_tr_b16 v[168:169], v16 offset:2048
 ds_read_b64_tr_b16 v[170:171], v16 offset:2560
 ds_read_b64_tr_b16 v[172:173], v17 offset:2048
 ds_read_b64_tr_b16 v[174:175], v17 offset:2560
 s_waitcnt lgkmcnt(4)
 v_mfma_f32_32x32x16_bf16 v[40:55], v[176:179], v[224:227], v[40:55]
 v_mfma_f32_32x32x16_bf16 v[56:71], v[176:179], v[228:231], v[56:71]
 v_mfma_f32_32x32x16_bf16 v[72:87], v[180:183], v[224:227], v[72:87]
 v_mfma_f32_32x32x16_bf16 v[88:103], v[180:183], v[228:231], v[88:103]
 s_waitcnt vmcnt(2)
 ds_read_b64_tr_b16 v[176:177], v16 offset:4096
 ds_read_b64_tr_b16 v[178:179], v16 offset:4608
 ds_read_b64_tr_b16 v[180:181], v17 offset:4096
 ds_read_b64_tr_b16 v[182:183], v17 offset:4608
 s_waitcnt lgkmcnt(4)
 v_mfma_f32_32x32x16_bf16 v[40:55], v[168:171], v[232:235], v[40:55]
 v_mfma_f32_32x32x16_bf16 v[56:71], v[168:171], v[236:239], v[56:71]
 v_mfma_f32_32x32x16_bf16 v[72:87], v[172:175], v[232:235], v[72:87]
 v_mfma_f32_32x32x16_bf16 v[88:103], v[172:175], v[236:239], v[88:103]
 s_waitcnt vmcnt(0)
 s_waitcnt lgkmcnt(0)
 v_mfma_f32_32x32x16_bf16 v[40:55], v[176:179], v[240:243], v[40:55]
 v_mfma_f32_32x32x16_bf16 v[56:71], v[176:179], v[244:247], v[56:71]
 v_mfma_f32_32x32x16_bf16 v[72:87], v[180:183], v[240:243], v[72:87]
 v_mfma_f32_32x32x16_bf16 v[88:103], v[180:183], v[244:247], v[88:103]
 s_setprio 2
 s_mul_i32 s41, s5, 14336
 s_add_u32 s41, s41, 0
 v_lshl_add_u32 v7, v1, 4, s41
 s_nop 5
 ds_write_b128 v7, v[56:59] offset:0
 ds_write_b128 v7, v[60:63] offset:1024
 ds_write_b128 v7, v[64:67] offset:2048
 ds_write_b128 v7, v[68:71] offset:3072
 ds_write_b128 v7, v[72:75] offset:4096
 ds_write_b128 v7, v[76:79] offset:5120
 ds_write_b128 v7, v[80:83] offset:6144
 ds_write_b128 v7, v[84:87] offset:7168
 ds_write_b128 v7, v[88:91] offset:8192
 ds_write_b128 v7, v[92:95] offset:9216
 ds_write_b128 v7, v[96:99] offset:10240
 ds_write_b128 v7, v[100:103] offset:11264
 s_waitcnt lgkmcnt(0)
 s_mov_b64 exec, 1
 v_mov_b32 v8, 162836
 v_mov_b32 v9, 1
 ds_add_u32 v8, v9
 s_mov_b64 exec, -1
 s_mul_i32 s39, s51, 28
 s_add_u32 s39, s39, s50
 s_lshl_b32 s38, s39, 1
 s_add_u32 s38, s38, s6
 s_lshl_b32 s38, s38, 12
 s_add_u32 s38, s38, 4718592
 s_lshl_b32 s39, s39, 2
 s_add_u32 s39, s39, s5
 s_lshl_b32 s39, s39, 7
 s_add_u32 s39, s39, 9437184
 s_and_b32 s36, s44, 1
 s_lshl_b32 s36, s36, 2
 s_lshr_b32 s4, s45, 3
 s_add_u32 s4, s4, s36
 s_cmp_ge_u32 s4, 7
 s_cbranch_scc1 L_end
 s_and_b32 s47, s45, 3
 s_lshr_b32 s3, s44, 1
 s_lshl_b32 s3, s3, 3
 s_and_b32 s36, s45, 7
 s_add_u32 s3, s3, s36
 s_lshl_b32 s49, s5, 2
 s_add_u32 s49, s49, s47
 s_sub_u32 s47, 4, s47
 s_mul_i32 s50, s49, 458752
 s_lshl_b32 s36, s3, 7
 s_add_u32 s50, s50, s36
 s_lshl_b32 s51, s4, 4
 s_add_u32 s51, s51, s49
 s_mul_i32 s51, s51, 14336
 s_add_u32 s51, s51, 4718592
 s_mul_i32 s52, s5, 100352
 s_lshl_b32 s36, s4, 7
 s_add_u32 s52, s52, s36
 s_lshl_b32 s53, s3, 2
 s_add_u32 s53, s53, s5
 s_lshl_b32 s55, s53, 10
 s_add_u32 s55, s55, 9568256
 s_mul_i32 s53, s53, 14336
 s_add_u32 s53, s53, 6815744
 s_lshl_b32 s54, s4, 2
 s_add_u32 s54, s54, s5
 s_mul_i32 s54, s54, 3584
 s_mov_b32 s49, 9437184
 v_lshrrev_b32 v7, 3, v1
 v_and_b32 v8, 7, v1
 v_lshrrev_b32 v9, 2, v1
 v_and_b32 v9, 4, v9
 v_xor_b32 v8, v8, v9
 v_mul_u32_u24 v7, 4096, v7
 v_lshl_add_u32 v10, v8, 4, v7
 v_add_u32 v11, 31744, v10
 s_add_u32 m0, s40, 0
 s_nop 0
 buffer_load_dwordx4 v10, s[20:23], s50 offen offset:0  lds
 buffer_load_dwordx4 v11, s[20:23], s50 offen offset:1024  lds
 s_add_u32 s50, s50, 65536
 s_add_u32 m0, s40, 2048
 s_nop 0
 buffer_load_dwordx4 v10, s[20:23], s50 offen offset:0  lds
 buffer_load_dwordx4 v11, s[20:23], s50 offen offset:1024  lds
 s_add_u32 s50, s50, 65536
 s_add_u32 m0, s40, 4096
 s_nop 0
 buffer_load_dwordx4 v10, s[20:23], s50 offen offset:0  lds
 buffer_load_dwordx4 v11, s[20:23], s50 offen offset:1024  lds
 s_add_u32 s50, s50, 65536
 s_add_u32 m0, s40, 6144
 s_nop 0
 buffer_load_dwordx4 v10, s[20:23], s50 offen offset:0  lds
 buffer_load_dwordx4 v11, s[20:23], s50 offen offset:1024  lds
 s_add_u32 s50, s50, 65536
 s_add_u32 m0, s40, 8192
 s_nop 0
 buffer_load_dwordx4 v10, s[20:23], s50 offen offset:0  lds
 buffer_load_dwordx4 v11, s[20:23], s50 offen offset:1024  lds
 s_add_u32 s50, s50, 65536
 v_mov_b32 v8, 162836
 s_mov_b32 s43, 0x400000
L_ll20:
 ds_read_b32 v9, v8
 s_waitcnt lgkmcnt(0)
 v_cmp_gt_u32 vcc, 4, v9
 s_sub_u32 s43, s43, 1
 s_cbranch_scc1 L_ld20
 s_cbranch_vccz L_ld20
 s_sleep 1
 s_branch L_ll20
L_ld20:
 s_xor_b32 s41, s5, 1
 s_mul_i32 s41, s41, 14336
 s_add_u32 s41, s41, 0
 v_lshl_add_u32 v7, v1, 4, s41
 ds_read_b128 v[56:59], v7 offset:0
 ds_read_b128 v[60:63], v7 offset:1024
 ds_read_b128 v[64:67], v7 offset:2048
 ds_read_b128 v[68:71], v7 offset:3072
 s_xor_b32 s41, s5, 2
 s_mul_i32 s41, s41, 14336
 s_add_u32 s41, s41, 0
 v_lshl_add_u32 v7, v1, 4, s41
 ds_read_b128 v[72:75], v7 offset:4096
 ds_read_b128 v[76:79], v7 offset:5120
 ds_read_b128 v[80:83], v7 offset:6144
 ds_read_b128 v[84:87], v7 offset:7168
 s_xor_b32 s41, s5, 3
 s_mul_i32 s41, s41, 14336
 s_add_u32 s41, s41, 0
 v_lshl_add_u32 v7, v1, 4, s41
 ds_read_b128 v[88:91], v7 offset:8192
 ds_read_b128 v[92:95], v7 offset:9216
 ds_read_b128 v[96:99], v7 offset:10240
 ds_read_b128 v[100:103], v7 offset:11264
 s_waitcnt lgkmcnt(8)
 v_pk_add_f32 v[40:41], v[40:41], v[56:57]
 v_pk_add_f32 v[42:43], v[42:43], v[58:59]
 v_pk_add_f32 v[44:45], v[44:45], v[60:61]
 v_pk_add_f32 v[46:47], v[46:47], v[62:63]
 v_pk_add_f32 v[48:49], v[48:49], v[64:65]
 v_pk_add_f32 v[50:51], v[50:51], v[66:67]
 v_pk_add_f32 v[52:53], v[52:53], v[68:69]
 v_pk_add_f32 v[54:55], v[54:55], v[70:71]
 s_waitcnt lgkmcnt(4)
 v_pk_add_f32 v[40:41], v[40:41], v[72:73]
 v_pk_add_f32 v[42:43], v[42:43], v[74:75]
 v_pk_add_f32 v[44:45], v[44:45], v[76:77]
 v_pk_add_f32 v[46:47], v[46:47], v[78:79]
 v_pk_add_f32 v[48:49], v[48:49], v[80:81]
 v_pk_add_f32 v[50:51], v[50:51], v[82:83]
 v_pk_add_f32 v[52:53], v[52:53], v[84:85]
 v_pk_add_f32 v[54:55], v[54:55], v[86:87]
 s_waitcnt lgkmcnt(0)
 v_pk_add_f32 v[40:41], v[40:41], v[88:89]
 v_pk_add_f32 v[42:43], v[42:43], v[90:91]
 v_pk_add_f32 v[44:45], v[44:45], v[92:93]
 v_pk_add_f32 v[46:47], v[46:47], v[94:95]
 v_pk_add_f32 v[48:49], v[48:49], v[96:97]
 v_pk_add_f32 v[50:51], v[50:51], v[98:99]
 v_pk_add_f32 v[52:53], v[52:53], v[100:101]
 v_pk_add_f32 v[54:55], v[54:55], v[102:103]
 s_waitcnt lgkmcnt(0)
 s_mov_b64 exec, 1
 v_mov_b32 v8, 162840
 v_mov_b32 v9, 1
 ds_add_u32 v8, v9
 s_mov_b64 exec, -1
 v_lshlrev_b32 v56, 16, v18
 v_and_b32 v57, 0xffff0000, v18
 v_lshlrev_b32 v58, 16, v19
 v_and_b32 v59, 0xffff0000, v19
 v_lshlrev_b32 v60, 16, v20
 v_and_b32 v61, 0xffff0000, v20
 v_lshlrev_b32 v62, 16, v21
 v_and_b32 v63, 0xffff0000, v21
 v_lshlrev_b32 v64, 16, v22
 v_and_b32 v65, 0xffff0000, v22
 v_lshlrev_b32 v66, 16, v23
 v_and_b32 v67, 0xffff0000, v23
 v_lshlrev_b32 v68, 16, v24
 v_and_b32 v69, 0xffff0000, v24
 v_lshlrev_b32 v70, 16, v25
 v_and_b32 v71, 0xffff0000, v25
 v_mov_b32 v8, -2.302208198144325
 v_mov_b32 v9, -0.1029432395800235
 v_pk_add_f32 v[40:41], v[40:41], v[56:57]
 v_pk_add_f32 v[42:43], v[42:43], v[58:59]
 v_pk_add_f32 v[44:45], v[44:45], v[60:61]
 v_pk_add_f32 v[46:47], v[46:47], v[62:63]
 v_pk_add_f32 v[48:49], v[48:49], v[64:65]
 v_pk_add_f32 v[50:51], v[50:51], v[66:67]
 v_pk_add_f32 v[52:53], v[52:53], v[68:69]
 v_pk_add_f32 v[54:55], v[54:55], v[70:71]
 v_pk_mul_f32 v[56:57], v[40:41], v[40:41]
 v_pk_mul_f32 v[58:59], v[42:43], v[42:43]
 v_pk_mul_f32 v[60:61], v[44:45], v[44:45]
 v_pk_mul_f32 v[62:63], v[46:47], v[46:47]
 v_pk_mul_f32 v[64:65], v[48:49], v[48:49]
 v_pk_mul_f32 v[66:67], v[50:51], v[50:51]
 v_pk_mul_f32 v[68:69], v[52:53], v[52:53]
 v_pk_mul_f32 v[70:71], v[54:55], v[54:55]
 v_pk_fma_f32 v[56:57], v[56:57], v[8:9], v[8:9] op_sel:[0,1,0] op_sel_hi:[1,1,0]
 v_pk_fma_f32 v[58:59], v[58:59], v[8:9], v[8:9] op_sel:[0,1,0] op_sel_hi:[1,1,0]
 v_pk_fma_f32 v[60:61], v[60:61], v[8:9], v[8:9] op_sel:[0,1,0] op_sel_hi:[1,1,0]
 v_pk_fma_f32 v[62:63], v[62:63], v[8:9], v[8:9] op_sel:[0,1,0] op_sel_hi:[1,1,0]
 v_pk_fma_f32 v[64:65], v[64:65], v[8:9], v[8:9] op_sel:[0,1,0] op_sel_hi:[1,1,0]
 v_pk_fma_f32 v[66:67], v[66:67], v[8:9], v[8:9] op_sel:[0,1,0] op_sel_hi:[1,1,0]
 v_pk_fma_f32 v[68:69], v[68:69], v[8:9], v[8:9] op_sel:[0,1,0] op_sel_hi:[1,1,0]
 v_pk_fma_f32 v[70:71], v[70:71], v[8:9], v[8:9] op_sel:[0,1,0] op_sel_hi:[1,1,0]
 v_pk_mul_f32 v[56:57], v[56:57], v[40:41]
 v_pk_mul_f32 v[58:59], v[58:59], v[42:43]
 v_pk_mul_f32 v[60:61], v[60:61], v[44:45]
 v_pk_mul_f32 v[62:63], v[62:63], v[46:47]
 v_pk_mul_f32 v[64:65], v[64:65], v[48:49]
 v_pk_mul_f32 v[66:67], v[66:67], v[50:51]
 v_pk_mul_f32 v[68:69], v[68:69], v[52:53]
 v_pk_mul_f32 v[70:71], v[70:71], v[54:55]
 v_exp_f32 v56, v56
 v_exp_f32 v57, v57
 v_exp_f32 v58, v58
 v_exp_f32 v59, v59
 v_exp_f32 v60, v60
 v_exp_f32 v61, v61
 v_exp_f32 v62, v62
 v_exp_f32 v63, v63
 v_exp_f32 v64, v64
 v_exp_f32 v65, v65
 v_exp_f32 v66, v66
 v_exp_f32 v67, v67
 v_exp_f32 v68, v68
 v_exp_f32 v69, v69
 v_exp_f32 v70, v70
 v_exp_f32 v71, v71
 v_pk_add_f32 v[56:57], v[56:57], 1.0 op_sel_hi:[1,0]
 v_pk_add_f32 v[58:59], v[58:59], 1.0 op_sel_hi:[1,0]
 v_pk_add_f32 v[60:61], v[60:61], 1.0 op_sel_hi:[1,0]
 v_pk_add_f32 v[62:63], v[62:63], 1.0 op_sel_hi:[1,0]
 v_pk_add_f32 v[64:65], v[64:65], 1.0 op_sel_hi:[1,0]
 v_pk_add_f32 v[66:67], v[66:67], 1.0 op_sel_hi:[1,0]
 v_pk_add_f32 v[68:69], v[68:69], 1.0 op_sel_hi:[1,0]
 v_pk_add_f32 v[70:71], v[70:71], 1.0 op_sel_hi:[1,0]
 v_rcp_f32 v56, v56
 v_rcp_f32 v57, v57
 v_rcp_f32 v58, v58
 v_rcp_f32 v59, v59
 v_rcp_f32 v60, v60
 v_rcp_f32 v61, v61
 v_rcp_f32 v62, v62
 v_rcp_f32 v63, v63
 v_rcp_f32 v64, v64
 v_rcp_f32 v65, v65
 v_rcp_f32 v66, v66
 v_rcp_f32 v67, v67
 v_rcp_f32 v68, v68
 v_rcp_f32 v69, v69
 v_rcp_f32 v70, v70
 v_rcp_f32 v71, v71
 v_pk_mul_f32 v[40:41], v[40:41], v[56:57]
 v_pk_mul_f32 v[42:43], v[42:43], v[58:59]
 v_pk_mul_f32 v[44:45], v[44:45], v[60:61]
 v_pk_mul_f32 v[46:47], v[46:47], v[62:63]
 v_pk_mul_f32 v[48:49], v[48:49], v[64:65]
 v_pk_mul_f32 v[50:51], v[50:51], v[66:67]
 v_pk_mul_f32 v[52:53], v[52:53], v[68:69]
 v_pk_mul_f32 v[54:55], v[54:55], v[70:71]
 v_cvt_pk_bf16_f32 v16, v40, v41
 v_cvt_pk_bf16_f32 v17, v42, v43
 v_cvt_pk_bf16_f32 v18, v44, v45
 v_cvt_pk_bf16_f32 v19, v46, v47
 v_cvt_pk_bf16_f32 v20, v48, v49
 v_cvt_pk_bf16_f32 v21, v50, v51
 v_cvt_pk_bf16_f32 v22, v52, v53
 v_cvt_pk_bf16_f32 v23, v54, v55
 buffer_store_dwordx4 v[16:19], v12, s[12:15], s38 offen offset:0 sc1
 buffer_store_dwordx4 v[20:23], v12, s[12:15], s38 offen offset:2048 sc1
 s_waitcnt vmcnt(0)
 s_mov_b64 exec, 1
 v_mov_b32 v8, 0
 v_mov_b32 v9, s60
 buffer_store_dword v9, v8, s[12:15], s39 offen offset:0 sc1
 s_mov_b64 exec, -1
 s_branch L_g2
L_pref:
 s_cmp_lt_u32 s45, 25
 s_cbranch_scc1 L_g2s
 s_setprio 1
 v_mov_b32 v8, 162876
 s_mov_b32 s43, 0x400000
L_ll21:
 ds_read_b32 v9, v8
 s_waitcnt lgkmcnt(0)
 v_cmp_gt_u32 vcc, 8, v9
 s_sub_u32 s43, s43, 1
 s_cbranch_scc1 L_ld21
 s_cbranch_vccz L_ld21
 s_sleep 1
 s_branch L_ll21
L_ld21:
 s_sub_u32 s41, s45, 25
 s_lshl_b32 s42, s41, 2
 s_add_u32 s42, s42, s5
 v_lshrrev_b32 v7, 3, v1
 v_mad_u32_u24 v7, v6, 56, v7
 v_mad_u32_u24 v7, v6, 56, v7
 v_and_b32 v8, 7, v1
 v_lshlrev_b32 v8, 7, v8
 s_lshr_b32 s43, s44, 1
 s_lshl_b32 s43, s43, 10
 s_mul_i32 s36, s5, 1835008
 s_add_u32 s43, s43, s36
 v_lshrrev_b32 v9, 2, v1
 v_lshl_add_u32 v9, s42, 4, v9
 v_mul_u32_u24 v9, 896, v9
 v_lshl_add_u32 v9, v6, 7, v9
 s_and_b32 s42, s44, 1
 s_mul_i32 s42, s42, 384
 s_bitcmp0_b32 s44, 0
 s_cbranch_scc1 L_pwo
 s_cmp_lt_u32 s41, 10
 s_cselect_b32 s36, 0, 0
 s_add_u32 s36, s36, s41
 v_lshl_add_u32 v10, s36, 3, v7
 v_subrev_u32 v11, 448, v10
 v_min_u32 v10, v10, v11
 v_lshl_add_u32 v10, v10, 12, v8
 s_add_u32 s41, s41, 7
 buffer_load_dword v254, v10, s[20:23], s43 offen offset:0
 s_waitcnt vmcnt(1)
 s_cmp_lt_u32 s41, 10
 s_cselect_b32 s36, 0, 0
 s_add_u32 s36, s36, s41
 v_lshl_add_u32 v10, s36, 3, v7
 v_subrev_u32 v11, 448, v10
 v_min_u32 v10, v10, v11
 v_lshl_add_u32 v10, v10, 12, v8
 s_add_u32 s41, s41, 7
 buffer_load_dword v253, v10, s[20:23], s43 offen offset:0
 s_waitcnt vmcnt(1)
 s_cmp_lt_u32 s41, 10
 s_cselect_b32 s36, 0, 0
 s_add_u32 s36, s36, s41
 v_lshl_add_u32 v10, s36, 3, v7
 v_subrev_u32 v11, 448, v10
 v_min_u32 v10, v10, v11
 v_lshl_add_u32 v10, v10, 12, v8
 s_add_u32 s41, s41, 7
 buffer_load_dword v252, v10, s[20:23], s43 offen offset:0
 s_waitcnt vmcnt(1)
 s_cmp_lt_u32 s41, 10
 s_cselect_b32 s36, 0, 0
 s_add_u32 s36, s36, s41
 v_lshl_add_u32 v10, s36, 3, v7
 v_subrev_u32 v11, 448, v10
 v_min_u32 v10, v10, v11
 v_lshl_add_u32 v10, v10, 12, v8
 s_add_u32 s41, s41, 7
 buffer_load_dword v251, v10, s[20:23], s43 offen offset:0
 s_waitcnt vmcnt(1)
 s_cmp_lt_u32 s41, 10
 s_cselect_b32 s36, 0, 0
 s_add_u32 s36, s36, s41
 v_lshl_add_u32 v10, s36, 3, v7
 v_subrev_u32 v11, 448, v10
 v_min_u32 v10, v10, v11
 v_lshl_add_u32 v10, v10, 12, v8
 s_add_u32 s41, s41, 7
 buffer_load_dword v250, v10, s[20:23], s43 offen offset:0
 s_waitcnt vmcnt(1)
 s_cmp_lt_u32 s41, 10
 s_cselect_b32 s36, 0, 0
 s_add_u32 s36, s36, s41
 v_lshl_add_u32 v10, s36, 3, v7
 v_subrev_u32 v11, 448, v10
 v_min_u32 v10, v10, v11
 v_lshl_add_u32 v10, v10, 12, v8
 s_add_u32 s41, s41, 7
 buffer_load_dword v249, v10, s[20:23], s43 offen offset:0
 s_waitcnt vmcnt(1)
 s_cmp_lt_u32 s41, 10
 s_cselect_b32 s36, 0, 0
 s_add_u32 s36, s36, s41
 v_lshl_add_u32 v10, s36, 3, v7
 v_subrev_u32 v11, 448, v10
 v_min_u32 v10, v10, v11
 v_lshl_add_u32 v10, v10, 12, v8
 s_add_u32 s41, s41, 7
 buffer_load_dword v248, v10, s[20:23], s43 offen offset:0
 s_waitcnt vmcnt(1)
 s_cmp_lt_u32 s41, 10
 s_cselect_b32 s36, 0, 0
 s_add_u32 s36, s36, s41
 v_lshl_add_u32 v10, s36, 3, v7
 v_subrev_u32 v11, 448, v10
 v_min_u32 v10, v10, v11
 v_lshl_add_u32 v10, v10, 12, v8
 s_add_u32 s41, s41, 7
 buffer_load_dword v247, v10, s[20:23], s43 offen offset:0
 s_waitcnt vmcnt(1)
L_pwo:
 buffer_load_dword v246, v9, s[24:27], s42 offen offset:0
L_g2s:
 s_setprio 2
 s_and_b32 s36, s44, 1
 s_lshl_b32 s36, s36, 2
 s_lshr_b32 s4, s45, 3
 s_add_u32 s4, s4, s36
 s_cmp_ge_u32 s4, 7
 s_cbranch_scc1 L_end
 s_and_b32 s47, s45, 3
 s_lshr_b32 s3, s44, 1
 s_lshl_b32 s3, s3, 3
 s_and_b32 s36, s45, 7
 s_add_u32 s3, s3, s36
 s_lshl_b32 s49, s5, 2
 s_add_u32 s49, s49, s47
 s_sub_u32 s47, 4, s47
 s_mul_i32 s50, s49, 458752
 s_lshl_b32 s36, s3, 7
 s_add_u32 s50, s50, s36
 s_lshl_b32 s51, s4, 4
 s_add_u32 s51, s51, s49
 s_mul_i32 s51, s51, 14336
 s_add_u32 s51, s51, 4718592
 s_mul_i32 s52, s5, 100352
 s_lshl_b32 s36, s4, 7
 s_add_u32 s52, s52, s36
 s_lshl_b32 s53, s3, 2
 s_add_u32 s53, s53, s5
 s_lshl_b32 s55, s53, 10
 s_add_u32 s55, s55, 9568256
 s_mul_i32 s53, s53, 14336
 s_add_u32 s53, s53, 6815744
 s_lshl_b32 s54, s4, 2
 s_add_u32 s54, s54, s5
 s_mul_i32 s54, s54, 3584
 s_mov_b32 s49, 9437184
 v_lshrrev_b32 v7, 3, v1
 v_and_b32 v8, 7, v1
 v_lshrrev_b32 v9, 2, v1
 v_and_b32 v9, 4, v9
 v_xor_b32 v8, v8, v9
 v_mul_u32_u24 v7, 4096, v7
 v_lshl_add_u32 v10, v8, 4, v7
 v_add_u32 v11, 31744, v10
 s_add_u32 m0, s40, 0
 s_nop 0
 buffer_load_dwordx4 v10, s[20:23], s50 offen offset:0  lds
 buffer_load_dwordx4 v11, s[20:23], s50 offen offset:1024  lds
 s_add_u32 s50, s50, 65536
 s_add_u32 m0, s40, 2048
 s_nop 0
 buffer_load_dwordx4 v10, s[20:23], s50 offen offset:0  lds
 buffer_load_dwordx4 v11, s[20:23], s50 offen offset:1024  lds
 s_add_u32 s50, s50, 65536
 s_add_u32 m0, s40, 4096
 s_nop 0
 buffer_load_dwordx4 v10, s[20:23], s50 offen offset:0  lds
 buffer_load_dwordx4 v11, s[20:23], s50 offen offset:1024  lds
 s_add_u32 s50, s50, 65536
 s_add_u32 m0, s40, 6144
 s_nop 0
 buffer_load_dwordx4 v10, s[20:23], s50 offen offset:0  lds
 buffer_load_dwordx4 v11, s[20:23], s50 offen offset:1024  lds
 s_add_u32 s50, s50, 65536
 s_add_u32 m0, s40, 8192
 s_nop 0
 buffer_load_dwordx4 v10, s[20:23], s50 offen offset:0  lds
 buffer_load_dwordx4 v11, s[20:23], s50 offen offset:1024  lds
 s_add_u32 s50, s50, 65536
L_g2:
 v_mad_u32_u24 v7, v2, 4, v4
 v_lshl_add_u32 v7, v7, 7, v5
 v_lshrrev_b32 v8, 1, v4
 v_xor_b32 v8, s7, v8
 v_lshl_add_u32 v7, v8, 6, v7
 v_xor_b32 v8, 64, v7
 v_add_u32 v14, s40, v7
 v_add_u32 v15, s40, v8
 v_add_u32 v16, s48, v7
 v_add_u32 v17, s48, v8
 v_lshrrev_b32 v7, 3, v1
 v_and_b32 v8, 7, v1
 v_lshrrev_b32 v9, 2, v1
 v_and_b32 v9, 4, v9
 v_xor_b32 v8, v8, v9
 v_mul_u32_u24 v7, 896, v7
 v_lshl_add_u32 v18, v8, 4, v7
 v_add_u32 v19, 6144, v18
 v_mad_u32_u24 v7, v2, 4, v4
 v_lshl_add_u32 v7, v7, 7, v5
 v_lshrrev_b32 v8, 1, v4
 v_xor_b32 v8, s6, v8
 v_lshl_add_u32 v7, v8, 6, v7
 v_xor_b32 v8, 64, v7
 v_add_u32 v20, s40, v7
 v_add_u32 v21, s40, v8
 v_add_u32 v22, s48, v7
 v_add_u32 v23, s48, v8
 v_lshlrev_b32 v7, 4, v1
 v_lshl_add_u32 v12, s7, 10, v7
 v_xor_b32 v13, 1024, v12
 v_lshlrev_b32 v7, 4, v1
 v_lshl_add_u32 v26, s6, 10, v7
 v_xor_b32 v27, 1024, v26
 s_lshl_b32 s36, s3, 1
 s_add_u32 s36, s36, s7
 v_lshl_add_u32 v28, s36, 5, v3
 v_lshlrev_b32 v34, 2, v28
 v_xor_b32 v35, 128, v34
 v_lshlrev_b32 v9, 1, v28
 s_lshl_b32 s36, s3, 9
 v_lshl_add_u32 v33, v6, 7, s36
 v_add_u32 v33, 262144, v33
 v_cmp_gt_u32 vcc, 28, v1
 v_lshl_add_u32 v32, v1, 7, s54
 s_mov_b32 s36, 8912896
 v_cndmask_b32 v32, v33, v32, vcc
 v_and_b32 v33, 7, v1
 v_lshlrev_b32 v33, 7, v33
 buffer_load_ushort v31, v9, s[28:31], 0 offen
 v_mov_b32 v8, 162840
 s_mov_b32 s43, 0x400000
L_ll22:
 ds_read_b32 v9, v8
 s_waitcnt lgkmcnt(0)
 v_cmp_gt_u32 vcc, s46, v9
 s_sub_u32 s43, s43, 1
 s_cbranch_scc1 L_ld22
 s_cbranch_vccz L_ld22
 s_sleep 1
 s_branch L_ll22
L_ld22:
 v_mov_b32 v8, 162856
 s_mov_b32 s43, 0x400000
L_ll23:
 ds_read_b32 v9, v8
 s_waitcnt lgkmcnt(0)
 v_cmp_gt_u32 vcc, 4, v9
 s_sub_u32 s43, s43, 1
 s_cbranch_scc1 L_ld23
 s_cbranch_vccz L_ld23
 s_sleep 1
 s_branch L_ll23
L_ld23:
 s_add_u32 m0, s48, 0
 s_nop 0
 buffer_load_dwordx4 v10, s[20:23], s50 offen offset:0  lds
 buffer_load_dwordx4 v11, s[20:23], s50 offen offset:1024  lds
 s_add_u32 s50, s50, 65536
 s_add_u32 m0, s48, 2048
 s_nop 0
 buffer_load_dwordx4 v10, s[20:23], s50 offen offset:0  lds
 buffer_load_dwordx4 v11, s[20:23], s50 offen offset:1024  lds
 s_add_u32 s50, s50, 65536
 s_cmp_eq_u32 s47, 1
 s_cselect_b32 s42, 1835008, 0
 s_sub_u32 s50, s50, s42
 s_add_u32 m0, s48, 4096
 s_nop 0
 buffer_load_dwordx4 v10, s[20:23], s50 offen offset:0  lds
 buffer_load_dwordx4 v11, s[20:23], s50 offen offset:1024  lds
 s_add_u32 s50, s50, 65536
 s_add_u32 m0, s48, 6144
 s_nop 0
 buffer_load_dwordx4 v10, s[20:23], s50 offen offset:0  lds
 buffer_load_dwordx4 v11, s[20:23], s50 offen offset:1024  lds
 s_add_u32 s50, s50, 65536
 s_add_u32 m0, s48, 8192
 s_nop 0
 buffer_load_dwordx4 v10, s[20:23], s50 offen offset:0  lds
 buffer_load_dwordx4 v11, s[20:23], s50 offen offset:1024  lds
 s_add_u32 s50, s50, 65536
 s_add_u32 m0, s48, 10240
 s_nop 0
 buffer_load_dwordx4 v10, s[20:23], s50 offen offset:0  lds
 buffer_load_dwordx4 v11, s[20:23], s50 offen offset:1024  lds
 s_add_u32 s50, s50, 65536
 s_add_u32 m0, s48, 12288
 s_nop 0
 buffer_load_dwordx4 v10, s[20:23], s50 offen offset:0  lds
 buffer_load_dwordx4 v11, s[20:23], s50 offen offset:1024  lds
 s_add_u32 s50, s50, 65536
 s_mov_b32 s43, 0x40000
L_pl24:
 buffer_load_dword v9, v32, s[12:15], s49 offen offset:0 sc1
 s_waitcnt vmcnt(0)
 v_cmp_ne_u32 vcc, s60, v9
 s_sub_u32 s43, s43, 1
 s_cbranch_scc1 L_pd24
 s_cbranch_vccz L_pd24
 s_mov_b64 exec, vcc
 s_sleep 2
 s_branch L_pl24
L_pd24:
 s_mov_b64 exec, -1
L_urdy:
 buffer_load_dword v29, v34, s[12:15], s36 offen offset:0 sc1
 buffer_load_dword v30, v35, s[12:15], s36 offen offset:0 sc1
 s_setprio 0
 buffer_load_dwordx4 v[184:187], v26, s[12:15], s51 offen offset:0 sc1
 buffer_load_dwordx4 v[188:191], v27, s[12:15], s51 offen offset:0 sc1
 s_add_u32 s51, s51, 2048
 buffer_load_dwordx4 v[192:195], v26, s[12:15], s51 offen offset:0 sc1
 buffer_load_dwordx4 v[196:199], v27, s[12:15], s51 offen offset:0 sc1
 s_add_u32 s51, s51, 2048
 buffer_load_dwordx4 v[200:203], v26, s[12:15], s51 offen offset:0 sc1
 buffer_load_dwordx4 v[204:207], v27, s[12:15], s51 offen offset:0 sc1
 s_add_u32 s51, s51, 2048
 buffer_load_dwordx4 v[208:211], v26, s[12:15], s51 offen offset:0 sc1
 buffer_load_dwordx4 v[212:215], v27, s[12:15], s51 offen offset:0 sc1
 s_add_u32 s51, s51, 2048
 ds_read_b64_tr_b16 v[168:169], v14 offset:0
 ds_read_b64_tr_b16 v[170:171], v14 offset:1024
 ds_read_b64_tr_b16 v[172:173], v15 offset:0
 ds_read_b64_tr_b16 v[174:175], v15 offset:1024
 s_waitcnt vmcnt(6)
 ds_read_b64_tr_b16 v[176:177], v14 offset:2048
 ds_read_b64_tr_b16 v[178:179], v14 offset:3072
 ds_read_b64_tr_b16 v[180:181], v15 offset:2048
 ds_read_b64_tr_b16 v[182:183], v15 offset:3072
 s_waitcnt lgkmcnt(4)
 v_mfma_f32_32x32x16_bf16 v[40:55], v[184:187], v[168:171], 0
 buffer_load_dwordx4 v[216:219], v26, s[12:15], s51 offen offset:0 sc1
 v_mfma_f32_32x32x16_bf16 v[56:71], v[184:187], v[172:175], 0
 buffer_load_dwordx4 v[220:223], v27, s[12:15], s51 offen offset:0 sc1
 v_mfma_f32_32x32x16_bf16 v[72:87], v[188:191], v[168:171], 0
 s_add_u32 s51, s51, 2048
 v_mfma_f32_32x32x16_bf16 v[88:103], v[188:191], v[172:175], 0
 s_waitcnt vmcnt(6)
 ds_read_b64_tr_b16 v[168:169], v14 offset:4096
 ds_read_b64_tr_b16 v[170:171], v14 offset:5120
 ds_read_b64_tr_b16 v[172:173], v15 offset:4096
 ds_read_b64_tr_b16 v[174:175], v15 offset:5120
 s_waitcnt lgkmcnt(4)
 v_mfma_f32_32x32x16_bf16 v[40:55], v[192:195], v[176:179], v[40:55]
 buffer_load_dwordx4 v[224:227], v26, s[12:15], s51 offen offset:0 sc1
 v_mfma_f32_32x32x16_bf16 v[56:71], v[192:195], v[180:183], v[56:71]
 buffer_load_dwordx4 v[228:231], v27, s[12:15], s51 offen offset:0 sc1
 v_mfma_f32_32x32x16_bf16 v[72:87], v[196:199], v[176:179], v[72:87]
 s_add_u32 s51, s51, 2048
 v_mfma_f32_32x32x16_bf16 v[88:103], v[196:199], v[180:183], v[88:103]
 s_waitcnt vmcnt(6)
 ds_read_b64_tr_b16 v[176:177], v14 offset:6144
 ds_read_b64_tr_b16 v[178:179], v14 offset:7168
 ds_read_b64_tr_b16 v[180:181], v15 offset:6144
 ds_read_b64_tr_b16 v[182:183], v15 offset:7168
 s_waitcnt lgkmcnt(4)
 v_mfma_f32_32x32x16_bf16 v[40:55], v[200:203], v[168:171], v[40:55]
 buffer_load_dwordx4 v[232:235], v26, s[12:15], s51 offen offset:0 sc1
 v_mfma_f32_32x32x16_bf16 v[56:71], v[200:203], v[172:175], v[56:71]
 buffer_load_dwordx4 v[236:239], v27, s[12:15], s51 offen offset:0 sc1
 v_mfma_f32_32x32x16_bf16 v[72:87], v[204:207], v[168:171], v[72:87]
 s_add_u32 s51, s51, 2048
 s_cmp_eq_u32 s47, 1
 s_cselect_b32 s42, 57344, 0
 s_sub_u32 s51, s51, s42
 v_mfma_f32_32x32x16_bf16 v[88:103], v[204:207], v[172:175], v[88:103]
 s_waitcnt vmcnt(6)
 ds_read_b64_tr_b16 v[168:169], v14 offset:8192
 ds_read_b64_tr_b16 v[170:171], v14 offset:9216
 ds_read_b64_tr_b16 v[172:173], v15 offset:8192
 ds_read_b64_tr_b16 v[174:175], v15 offset:9216
 s_waitcnt lgkmcnt(4)
 v_mfma_f32_32x32x16_bf16 v[40:55], v[208:211], v[176:179], v[40:55]
 buffer_load_dwordx4 v[240:243], v26, s[12:15], s51 offen offset:0 sc1
 v_mfma_f32_32x32x16_bf16 v[56:71], v[208:211], v[180:183], v[56:71]
 buffer_load_dwordx4 v[244:247], v27, s[12:15], s51 offen offset:0 sc1
 v_mfma_f32_32x32x16_bf16 v[72:87], v[212:215], v[176:179], v[72:87]
 s_add_u32 s51, s51, 2048
 v_mfma_f32_32x32x16_bf16 v[88:103], v[212:215], v[180:183], v[88:103]
 s_waitcnt vmcnt(6)
 ds_read_b64_tr_b16 v[176:177], v16 offset:0
 ds_read_b64_tr_b16 v[178:179], v16 offset:1024
 ds_read_b64_tr_b16 v[180:181], v17 offset:0
 ds_read_b64_tr_b16 v[182:183], v17 offset:1024
 s_waitcnt lgkmcnt(4)
 v_mfma_f32_32x32x16_bf16 v[40:55], v[216:219], v[168:171], v[40:55]
 buffer_load_dwordx4 v[184:187], v26, s[12:15], s51 offen offset:0 sc1
 v_mfma_f32_32x32x16_bf16 v[56:71], v[216:219], v[172:175], v[56:71]
 buffer_load_dwordx4 v[188:191], v27, s[12:15], s51 offen offset:0 sc1
 v_mfma_f32_32x32x16_bf16 v[72:87], v[220:223], v[168:171], v[72:87]
 s_add_u32 s51, s51, 2048
 v_mfma_f32_32x32x16_bf16 v[88:103], v[220:223], v[172:175], v[88:103]
 s_waitcnt vmcnt(6)
 ds_read_b64_tr_b16 v[168:169], v16 offset:2048
 ds_read_b64_tr_b16 v[170:171], v16 offset:3072
 ds_read_b64_tr_b16 v[172:173], v17 offset:2048
 ds_read_b64_tr_b16 v[174:175], v17 offset:3072
 s_waitcnt lgkmcnt(4)
 v_mfma_f32_32x32x16_bf16 v[40:55], v[224:227], v[176:179], v[40:55]
 buffer_load_dwordx4 v[192:195], v26, s[12:15], s51 offen offset:0 sc1
 v_mfma_f32_32x32x16_bf16 v[56:71], v[224:227], v[180:183], v[56:71]
 buffer_load_dwordx4 v[196:199], v27, s[12:15], s51 offen offset:0 sc1
 v_mfma_f32_32x32x16_bf16 v[72:87], v[228:231], v[176:179], v[72:87]
 s_add_u32 s51, s51, 2048
 v_mfma_f32_32x32x16_bf16 v[88:103], v[228:231], v[180:183], v[88:103]
 s_waitcnt vmcnt(6)
 ds_read_b64_tr_b16 v[176:177], v16 offset:4096
 ds_read_b64_tr_b16 v[178:179], v16 offset:5120
 ds_read_b64_tr_b16 v[180:181], v17 offset:4096
 ds_read_b64_tr_b16 v[182:183], v17 offset:5120
 s_waitcnt lgkmcnt(4)
 v_mfma_f32_32x32x16_bf16 v[40:55], v[232:235], v[168:171], v[40:55]
 buffer_load_dwordx4 v[200:203], v26, s[12:15], s51 offen offset:0 sc1
 v_mfma_f32_32x32x16_bf16 v[56:71], v[232:235], v[172:175], v[56:71]
 buffer_load_dwordx4 v[204:207], v27, s[12:15], s51 offen offset:0 sc1
 v_mfma_f32_32x32x16_bf16 v[72:87], v[236:239], v[168:171], v[72:87]
 s_add_u32 s51, s51, 2048
 s_add_u32 m0, s40, 0
 s_nop 0
 buffer_load_dwordx4 v10, s[20:23], s50 offen offset:0  lds
 v_mfma_f32_32x32x16_bf16 v[88:103], v[236:239], v[172:175], v[88:103]
 buffer_load_dwordx4 v11, s[20:23], s50 offen offset:1024  lds
 s_add_u32 s50, s50, 65536
 s_waitcnt vmcnt(8)
 ds_read_b64_tr_b16 v[168:169], v16 offset:6144
 ds_read_b64_tr_b16 v[170:171], v16 offset:7168
 ds_read_b64_tr_b16 v[172:173], v17 offset:6144
 ds_read_b64_tr_b16 v[174:175], v17 offset:7168
 s_waitcnt lgkmcnt(4)
 v_mfma_f32_32x32x16_bf16 v[40:55], v[240:243], v[176:179], v[40:55]
 buffer_load_dwordx4 v[208:211], v26, s[12:15], s51 offen offset:0 sc1
 v_mfma_f32_32x32x16_bf16 v[56:71], v[240:243], v[180:183], v[56:71]
 buffer_load_dwordx4 v[212:215], v27, s[12:15], s51 offen offset:0 sc1
 v_mfma_f32_32x32x16_bf16 v[72:87], v[244:247], v[176:179], v[72:87]
 s_add_u32 s51, s51, 2048
 s_add_u32 m0, s40, 2048
 s_nop 0
 buffer_load_dwordx4 v10, s[20:23], s50 offen offset:0  lds
 v_mfma_f32_32x32x16_bf16 v[88:103], v[244:247], v[180:183], v[88:103]
 buffer_load_dwordx4 v11, s[20:23], s50 offen offset:1024  lds
 s_add_u32 s50, s50, 65536
 s_cmp_eq_u32 s47, 2
 s_cselect_b32 s42, 1835008, 0
 s_sub_u32 s50, s50, s42
 s_waitcnt vmcnt(10)
 ds_read_b64_tr_b16 v[176:177], v16 offset:8192
 ds_read_b64_tr_b16 v[178:179], v16 offset:9216
 ds_read_b64_tr_b16 v[180:181], v17 offset:8192
 ds_read_b64_tr_b16 v[182:183], v17 offset:9216
 s_waitcnt lgkmcnt(4)
 v_mfma_f32_32x32x16_bf16 v[40:55], v[184:187], v[168:171], v[40:55]
 buffer_load_dwordx4 v[216:219], v26, s[12:15], s51 offen offset:0 sc1
 v_mfma_f32_32x32x16_bf16 v[56:71], v[184:187], v[172:175], v[56:71]
 buffer_load_dwordx4 v[220:223], v27, s[12:15], s51 offen offset:0 sc1
 v_mfma_f32_32x32x16_bf16 v[72:87], v[188:191], v[168:171], v[72:87]
 s_add_u32 s51, s51, 2048
 s_add_u32 m0, s40, 4096
 s_nop 0
 buffer_load_dwordx4 v10, s[20:23], s50 offen offset:0  lds
 v_mfma_f32_32x32x16_bf16 v[88:103], v[188:191], v[172:175], v[88:103]
 buffer_load_dwordx4 v11, s[20:23], s50 offen offset:1024  lds
 s_add_u32 s50, s50, 65536
 s_waitcnt vmcnt(12)
 ds_read_b64_tr_b16 v[168:169], v16 offset:10240
 ds_read_b64_tr_b16 v[170:171], v16 offset:11264
 ds_read_b64_tr_b16 v[172:173], v17 offset:10240
 ds_read_b64_tr_b16 v[174:175], v17 offset:11264
 s_waitcnt lgkmcnt(4)
 v_mfma_f32_32x32x16_bf16 v[40:55], v[192:195], v[176:179], v[40:55]
 buffer_load_dwordx4 v[224:227], v26, s[12:15], s51 offen offset:0 sc1
 v_mfma_f32_32x32x16_bf16 v[56:71], v[192:195], v[180:183], v[56:71]
 buffer_load_dwordx4 v[228:231], v27, s[12:15], s51 offen offset:0 sc1
 v_mfma_f32_32x32x16_bf16 v[72:87], v[196:199], v[176:179], v[72:87]
 s_add_u32 s51, s51, 2048
 s_cmp_eq_u32 s47, 2
 s_cselect_b32 s42, 57344, 0
 s_sub_u32 s51, s51, s42
 s_add_u32 m0, s40, 6144
 s_nop 0
 buffer_load_dwordx4 v10, s[20:23], s50 offen offset:0  lds
 v_mfma_f32_32x32x16_bf16 v[88:103], v[196:199], v[180:183], v[88:103]
 buffer_load_dwordx4 v11, s[20:23], s50 offen offset:1024  lds
 s_add_u32 s50, s50, 65536
 s_waitcnt vmcnt(14)
 ds_read_b64_tr_b16 v[176:177], v16 offset:12288
 ds_read_b64_tr_b16 v[178:179], v16 offset:13312
 ds_read_b64_tr_b16 v[180:181], v17 offset:12288
 ds_read_b64_tr_b16 v[182:183], v17 offset:13312
 s_waitcnt lgkmcnt(4)
 v_mfma_f32_32x32x16_bf16 v[40:55], v[200:203], v[168:171], v[40:55]
 buffer_load_dwordx4 v[232:235], v26, s[12:15], s51 offen offset:0 sc1
 v_mfma_f32_32x32x16_bf16 v[56:71], v[200:203], v[172:175], v[56:71]
 buffer_load_dwordx4 v[236:239], v27, s[12:15], s51 offen offset:0 sc1
 v_mfma_f32_32x32x16_bf16 v[72:87], v[204:207], v[168:171], v[72:87]
 s_add_u32 s51, s51, 2048
 s_add_u32 m0, s40, 8192
 s_nop 0
 buffer_load_dwordx4 v10, s[20:23], s50 offen offset:0  lds
 v_mfma_f32_32x32x16_bf16 v[88:103], v[204:207], v[172:175], v[88:103]
 buffer_load_dwordx4 v11, s[20:23], s50 offen offset:1024  lds
 s_add_u32 s50, s50, 65536
 s_waitcnt vmcnt(14)
 ds_read_b64_tr_b16 v[168:169], v14 offset:0
 ds_read_b64_tr_b16 v[170:171], v14 offset:1024
 ds_read_b64_tr_b16 v[172:173], v15 offset:0
 ds_read_b64_tr_b16 v[174:175], v15 offset:1024
 s_waitcnt lgkmcnt(4)
 v_mfma_f32_32x32x16_bf16 v[40:55], v[208:211], v[176:179], v[40:55]
 buffer_load_dwordx4 v[240:243], v26, s[12:15], s51 offen offset:0 sc1
 v_mfma_f32_32x32x16_bf16 v[56:71], v[208:211], v[180:183], v[56:71]
 buffer_load_dwordx4 v[244:247], v27, s[12:15], s51 offen offset:0 sc1
 v_mfma_f32_32x32x16_bf16 v[72:87], v[212:215], v[176:179], v[72:87]
 s_add_u32 s51, s51, 2048
 s_add_u32 m0, s48, 0
 s_nop 0
 buffer_load_dwordx4 v10, s[20:23], s50 offen offset:0  lds
 v_mfma_f32_32x32x16_bf16 v[88:103], v[212:215], v[180:183], v[88:103]
 buffer_load_dwordx4 v11, s[20:23], s50 offen offset:1024  lds
 s_add_u32 s50, s50, 65536
 s_waitcnt vmcnt(14)
 ds_read_b64_tr_b16 v[176:177], v14 offset:2048
 ds_read_b64_tr_b16 v[178:179], v14 offset:3072
 ds_read_b64_tr_b16 v[180:181], v15 offset:2048
 ds_read_b64_tr_b16 v[182:183], v15 offset:3072
 s_waitcnt lgkmcnt(4)
 v_mfma_f32_32x32x16_bf16 v[40:55], v[216:219], v[168:171], v[40:55]
 buffer_load_dwordx4 v[184:187], v26, s[12:15], s51 offen offset:0 sc1
 v_mfma_f32_32x32x16_bf16 v[56:71], v[216:219], v[172:175], v[56:71]
 buffer_load_dwordx4 v[188:191], v27, s[12:15], s51 offen offset:0 sc1
 v_mfma_f32_32x32x16_bf16 v[72:87], v[220:223], v[168:171], v[72:87]
 s_add_u32 s51, s51, 2048
 s_add_u32 m0, s48, 2048
 s_nop 0
 buffer_load_dwordx4 v10, s[20:23], s50 offen offset:0  lds
 v_mfma_f32_32x32x16_bf16 v[88:103], v[220:223], v[172:175], v[88:103]
 buffer_load_dwordx4 v11, s[20:23], s50 offen offset:1024  lds
 s_add_u32 s50, s50, 65536
 s_waitcnt vmcnt(14)
 ds_read_b64_tr_b16 v[168:169], v14 offset:4096
 ds_read_b64_tr_b16 v[170:171], v14 offset:5120
 ds_read_b64_tr_b16 v[172:173], v15 offset:4096
 ds_read_b64_tr_b16 v[174:175], v15 offset:5120
 s_waitcnt lgkmcnt(4)
 v_mfma_f32_32x32x16_bf16 v[40:55], v[224:227], v[176:179], v[40:55]
 buffer_load_dwordx4 v[192:195], v26, s[12:15], s51 offen offset:0 sc1
 v_mfma_f32_32x32x16_bf16 v[56:71], v[224:227], v[180:183], v[56:71]
 buffer_load_dwordx4 v[196:199], v27, s[12:15], s51 offen offset:0 sc1
 v_mfma_f32_32x32x16_bf16 v[72:87], v[228:231], v[176:179], v[72:87]
 s_add_u32 s51, s51, 2048
 s_add_u32 m0, s48, 4096
 s_nop 0
 buffer_load_dwordx4 v10, s[20:23], s50 offen offset:0  lds
 v_mfma_f32_32x32x16_bf16 v[88:103], v[228:231], v[180:183], v[88:103]
 buffer_load_dwordx4 v11, s[20:23], s50 offen offset:1024  lds
 s_add_u32 s50, s50, 65536
 s_waitcnt vmcnt(14)
 ds_read_b64_tr_b16 v[176:177], v14 offset:6144
 ds_read_b64_tr_b16 v[178:179], v14 offset:7168
 ds_read_b64_tr_b16 v[180:181], v15 offset:6144
 ds_read_b64_tr_b16 v[182:183], v15 offset:7168
 s_waitcnt lgkmcnt(4)
 v_mfma_f32_32x32x16_bf16 v[40:55], v[232:235], v[168:171], v[40:55]
 buffer_load_dwordx4 v[200:203], v26, s[12:15], s51 offen offset:0 sc1
 v_mfma_f32_32x32x16_bf16 v[56:71], v[232:235], v[172:175], v[56:71]
 buffer_load_dwordx4 v[204:207], v27, s[12:15], s51 offen offset:0 sc1
 v_mfma_f32_32x32x16_bf16 v[72:87], v[236:239], v[168:171], v[72:87]
 s_add_u32 s51, s51, 2048
 s_add_u32 m0, s48, 6144
 s_nop 0
 buffer_load_dwordx4 v10, s[20:23], s50 offen offset:0  lds
 v_mfma_f32_32x32x16_bf16 v[88:103], v[236:239], v[172:175], v[88:103]
 buffer_load_dwordx4 v11, s[20:23], s50 offen offset:1024  lds
 s_add_u32 s50, s50, 65536
 s_cmp_eq_u32 s47, 3
 s_cselect_b32 s42, 1835008, 0
 s_sub_u32 s50, s50, s42
 s_waitcnt vmcnt(14)
 ds_read_b64_tr_b16 v[168:169], v14 offset:8192
 ds_read_b64_tr_b16 v[170:171], v14 offset:9216
 ds_read_b64_tr_b16 v[172:173], v15 offset:8192
 ds_read_b64_tr_b16 v[174:175], v15 offset:9216
 s_waitcnt lgkmcnt(4)
 v_mfma_f32_32x32x16_bf16 v[40:55], v[240:243], v[176:179], v[40:55]
 buffer_load_dwordx4 v[208:211], v26, s[12:15], s51 offen offset:0 sc1
 v_mfma_f32_32x32x16_bf16 v[56:71], v[240:243], v[180:183], v[56:71]
 buffer_load_dwordx4 v[212:215], v27, s[12:15], s51 offen offset:0 sc1
 v_mfma_f32_32x32x16_bf16 v[72:87], v[244:247], v[176:179], v[72:87]
 s_add_u32 s51, s51, 2048
 s_add_u32 m0, s48, 8192
 s_nop 0
 buffer_load_dwordx4 v10, s[20:23], s50 offen offset:0  lds
 v_mfma_f32_32x32x16_bf16 v[88:103], v[244:247], v[180:183], v[88:103]
 buffer_load_dwordx4 v11, s[20:23], s50 offen offset:1024  lds
 s_add_u32 s50, s50, 65536
 s_waitcnt vmcnt(14)
 ds_read_b64_tr_b16 v[176:177], v16 offset:0
 ds_read_b64_tr_b16 v[178:179], v16 offset:1024
 ds_read_b64_tr_b16 v[180:181], v17 offset:0
 ds_read_b64_tr_b16 v[182:183], v17 offset:1024
 s_waitcnt lgkmcnt(4)
 v_mfma_f32_32x32x16_bf16 v[40:55], v[184:187], v[168:171], v[40:55]
 buffer_load_dwordx4 v[216:219], v26, s[12:15], s51 offen offset:0 sc1
 v_mfma_f32_32x32x16_bf16 v[56:71], v[184:187], v[172:175], v[56:71]
 buffer_load_dwordx4 v[220:223], v27, s[12:15], s51 offen offset:0 sc1
 v_mfma_f32_32x32x16_bf16 v[72:87], v[188:191], v[168:171], v[72:87]
 s_add_u32 s51, s51, 2048
 s_cmp_eq_u32 s47, 3
 s_cselect_b32 s42, 57344, 0
 s_sub_u32 s51, s51, s42
 s_add_u32 m0, s48, 10240
 s_nop 0
 buffer_load_dwordx4 v10, s[20:23], s50 offen offset:0  lds
 v_mfma_f32_32x32x16_bf16 v[88:103], v[188:191], v[172:175], v[88:103]
 buffer_load_dwordx4 v11, s[20:23], s50 offen offset:1024  lds
 s_add_u32 s50, s50, 65536
 s_waitcnt vmcnt(14)
 ds_read_b64_tr_b16 v[168:169], v16 offset:2048
 ds_read_b64_tr_b16 v[170:171], v16 offset:3072
 ds_read_b64_tr_b16 v[172:173], v17 offset:2048
 ds_read_b64_tr_b16 v[174:175], v17 offset:3072
 s_waitcnt lgkmcnt(4)
 v_mfma_f32_32x32x16_bf16 v[40:55], v[192:195], v[176:179], v[40:55]
 buffer_load_dwordx4 v[224:227], v26, s[12:15], s51 offen offset:0 sc1
 v_mfma_f32_32x32x16_bf16 v[56:71], v[192:195], v[180:183], v[56:71]
 buffer_load_dwordx4 v[228:231], v27, s[12:15], s51 offen offset:0 sc1
 v_mfma_f32_32x32x16_bf16 v[72:87], v[196:199], v[176:179], v[72:87]
 s_add_u32 s51, s51, 2048
 s_add_u32 m0, s48, 12288
 s_nop 0
 buffer_load_dwordx4 v10, s[20:23], s50 offen offset:0  lds
 v_mfma_f32_32x32x16_bf16 v[88:103], v[196:199], v[180:183], v[88:103]
 buffer_load_dwordx4 v11, s[20:23], s50 offen offset:1024  lds
 s_add_u32 s50, s50, 65536
 s_waitcnt vmcnt(14)
 ds_read_b64_tr_b16 v[176:177], v16 offset:4096
 ds_read_b64_tr_b16 v[178:179], v16 offset:5120
 ds_read_b64_tr_b16 v[180:181], v17 offset:4096
 ds_read_b64_tr_b16 v[182:183], v17 offset:5120
 s_waitcnt lgkmcnt(4)
 v_mfma_f32_32x32x16_bf16 v[40:55], v[200:203], v[168:171], v[40:55]
 buffer_load_dwordx4 v[232:235], v26, s[12:15], s51 offen offset:0 sc1
 v_mfma_f32_32x32x16_bf16 v[56:71], v[200:203], v[172:175], v[56:71]
 buffer_load_dwordx4 v[236:239], v27, s[12:15], s51 offen offset:0 sc1
 v_mfma_f32_32x32x16_bf16 v[72:87], v[204:207], v[168:171], v[72:87]
 s_add_u32 s51, s51, 2048
 s_add_u32 m0, s40, 0
 s_nop 0
 buffer_load_dwordx4 v10, s[20:23], s50 offen offset:0  lds
 v_mfma_f32_32x32x16_bf16 v[88:103], v[204:207], v[172:175], v[88:103]
 buffer_load_dwordx4 v11, s[20:23], s50 offen offset:1024  lds
 s_add_u32 s50, s50, 65536
 s_waitcnt vmcnt(14)
 ds_read_b64_tr_b16 v[168:169], v16 offset:6144
 ds_read_b64_tr_b16 v[170:171], v16 offset:7168
 ds_read_b64_tr_b16 v[172:173], v17 offset:6144
 ds_read_b64_tr_b16 v[174:175], v17 offset:7168
 s_waitcnt lgkmcnt(4)
 v_mfma_f32_32x32x16_bf16 v[40:55], v[208:211], v[176:179], v[40:55]
 buffer_load_dwordx4 v[240:243], v26, s[12:15], s51 offen offset:0 sc1
 v_mfma_f32_32x32x16_bf16 v[56:71], v[208:211], v[180:183], v[56:71]
 buffer_load_dwordx4 v[244:247], v27, s[12:15], s51 offen offset:0 sc1
 v_mfma_f32_32x32x16_bf16 v[72:87], v[212:215], v[176:179], v[72:87]
 s_add_u32 s51, s51, 2048
 s_add_u32 m0, s40, 2048
 s_nop 0
 buffer_load_dwordx4 v10, s[20:23], s50 offen offset:0  lds
 v_mfma_f32_32x32x16_bf16 v[88:103], v[212:215], v[180:183], v[88:103]
 buffer_load_dwordx4 v11, s[20:23], s50 offen offset:1024  lds
 s_add_u32 s50, s50, 65536
 s_waitcnt vmcnt(14)
 ds_read_b64_tr_b16 v[176:177], v16 offset:8192
 ds_read_b64_tr_b16 v[178:179], v16 offset:9216
 ds_read_b64_tr_b16 v[180:181], v17 offset:8192
 ds_read_b64_tr_b16 v[182:183], v17 offset:9216
 s_waitcnt lgkmcnt(4)
 v_mfma_f32_32x32x16_bf16 v[40:55], v[216:219], v[168:171], v[40:55]
 buffer_load_dwordx4 v[184:187], v26, s[12:15], s51 offen offset:0 sc1
 v_mfma_f32_32x32x16_bf16 v[56:71], v[216:219], v[172:175], v[56:71]
 buffer_load_dwordx4 v[188:191], v27, s[12:15], s51 offen offset:0 sc1
 v_mfma_f32_32x32x16_bf16 v[72:87], v[220:223], v[168:171], v[72:87]
 s_add_u32 s51, s51, 2048
 s_add_u32 m0, s40, 4096
 s_nop 0
 buffer_load_dwordx4 v10, s[20:23], s50 offen offset:0  lds
 v_mfma_f32_32x32x16_bf16 v[88:103], v[220:223], v[172:175], v[88:103]
 buffer_load_dwordx4 v11, s[20:23], s50 offen offset:1024  lds
 s_add_u32 s50, s50, 65536
 s_waitcnt vmcnt(14)
 ds_read_b64_tr_b16 v[168:169], v16 offset:10240
 ds_read_b64_tr_b16 v[170:171], v16 offset:11264
 ds_read_b64_tr_b16 v[172:173], v17 offset:10240
 ds_read_b64_tr_b16 v[174:175], v17 offset:11264
 s_waitcnt lgkmcnt(4)
 v_mfma_f32_32x32x16_bf16 v[40:55], v[224:227], v[176:179], v[40:55]
 buffer_load_dwordx4 v[192:195], v26, s[12:15], s51 offen offset:0 sc1
 v_mfma_f32_32x32x16_bf16 v[56:71], v[224:227], v[180:183], v[56:71]
 buffer_load_dwordx4 v[196:199], v27, s[12:15], s51 offen offset:0 sc1
 v_mfma_f32_32x32x16_bf16 v[72:87], v[228:231], v[176:179], v[72:87]
 s_add_u32 s51, s51, 2048
 s_add_u32 m0, s40, 6144
 s_nop 0
 buffer_load_dwordx4 v10, s[20:23], s50 offen offset:0  lds
 v_mfma_f32_32x32x16_bf16 v[88:103], v[228:231], v[180:183], v[88:103]
 buffer_load_dwordx4 v11, s[20:23], s50 offen offset:1024  lds
 s_add_u32 s50, s50, 65536
 s_waitcnt vmcnt(14)
 ds_read_b64_tr_b16 v[176:177], v16 offset:12288
 ds_read_b64_tr_b16 v[178:179], v16 offset:13312
 ds_read_b64_tr_b16 v[180:181], v17 offset:12288
 ds_read_b64_tr_b16 v[182:183], v17 offset:13312
 s_waitcnt lgkmcnt(4)
 v_mfma_f32_32x32x16_bf16 v[40:55], v[232:235], v[168:171], v[40:55]
 buffer_load_dwordx4 v[200:203], v26, s[12:15], s51 offen offset:0 sc1
 v_mfma_f32_32x32x16_bf16 v[56:71], v[232:235], v[172:175], v[56:71]
 buffer_load_dwordx4 v[204:207], v27, s[12:15], s51 offen offset:0 sc1
 v_mfma_f32_32x32x16_bf16 v[72:87], v[236:239], v[168:171], v[72:87]
 s_add_u32 s51, s51, 2048
 s_add_u32 m0, s40, 8192
 s_nop 0
 buffer_load_dwordx4 v18, s[24:27], s52 offen offset:0  lds
 v_mfma_f32_32x32x16_bf16 v[88:103], v[236:239], v[172:175], v[88:103]
 buffer_load_dwordx4 v19, s[24:27], s52 offen offset:1024  lds
 s_add_u32 s52, s52, 14336
 s_waitcnt vmcnt(14)
 ds_read_b64_tr_b16 v[168:169], v14 offset:0
 ds_read_b64_tr_b16 v[170:171], v14 offset:1024
 ds_read_b64_tr_b16 v[172:173], v15 offset:0
 ds_read_b64_tr_b16 v[174:175], v15 offset:1024
 s_waitcnt lgkmcnt(4)
 v_mfma_f32_32x32x16_bf16 v[40:55], v[240:243], v[176:179], v[40:55]
 buffer_load_dwordx4 v[208:211], v26, s[12:15], s51 offen offset:0 sc1
 v_mfma_f32_32x32x16_bf16 v[56:71], v[240:243], v[180:183], v[56:71]
 buffer_load_dwordx4 v[212:215], v27, s[12:15], s51 offen offset:0 sc1
 v_mfma_f32_32x32x16_bf16 v[72:87], v[244:247], v[176:179], v[72:87]
 s_add_u32 s51, s51, 2048
 s_add_u32 m0, s48, 0
 s_nop 0
 buffer_load_dwordx4 v18, s[24:27], s52 offen offset:0  lds
 v_mfma_f32_32x32x16_bf16 v[88:103], v[244:247], v[180:183], v[88:103]
 buffer_load_dwordx4 v19, s[24:27], s52 offen offset:1024  lds
 s_add_u32 s52, s52, 14336
 buffer_load_dword v36, v33, s[12:15], s55 offen offset:0 sc1
 s_waitcnt vmcnt(15)
 ds_read_b64_tr_b16 v[176:177], v14 offset:2048
 ds_read_b64_tr_b16 v[178:179], v14 offset:3072
 ds_read_b64_tr_b16 v[180:181], v15 offset:2048
 ds_read_b64_tr_b16 v[182:183], v15 offset:3072
 s_waitcnt lgkmcnt(4)
 v_mfma_f32_32x32x16_bf16 v[40:55], v[184:187], v[168:171], v[40:55]
 v_mfma_f32_32x32x16_bf16 v[56:71], v[184:187], v[172:175], v[56:71]
 v_mfma_f32_32x32x16_bf16 v[72:87], v[188:191], v[168:171], v[72:87]
 v_mfma_f32_32x32x16_bf16 v[88:103], v[188:191], v[172:175], v[88:103]
 s_add_u32 m0, s48, 2048
 s_nop 0
 buffer_load_dwordx4 v18, s[24:27], s52 offen offset:0  lds
 buffer_load_dwordx4 v19, s[24:27], s52 offen offset:1024  lds
 s_add_u32 s52, s52, 14336
 s_waitcnt vmcnt(13)
 ds_read_b64_tr_b16 v[168:169], v14 offset:4096
 ds_read_b64_tr_b16 v[170:171], v14 offset:5120
 ds_read_b64_tr_b16 v[172:173], v15 offset:4096
 ds_read_b64_tr_b16 v[174:175], v15 offset:5120
 s_waitcnt lgkmcnt(4)
 v_mfma_f32_32x32x16_bf16 v[40:55], v[192:195], v[176:179], v[40:55]
 v_mfma_f32_32x32x16_bf16 v[56:71], v[192:195], v[180:183], v[56:71]
 v_mfma_f32_32x32x16_bf16 v[72:87], v[196:199], v[176:179], v[72:87]
 v_mfma_f32_32x32x16_bf16 v[88:103], v[196:199], v[180:183], v[88:103]
 s_add_u32 m0, s48, 4096
 s_nop 0
 buffer_load_dwordx4 v18, s[24:27], s52 offen offset:0  lds
 buffer_load_dwordx4 v19, s[24:27], s52 offen offset:1024  lds
 s_add_u32 s52, s52, 14336
 s_waitcnt vmcnt(11)
 ds_read_b64_tr_b16 v[176:177], v14 offset:6144
 ds_read_b64_tr_b16 v[178:179], v14 offset:7168
 ds_read_b64_tr_b16 v[180:181], v15 offset:6144
 ds_read_b64_tr_b16 v[182:183], v15 offset:7168
 s_waitcnt lgkmcnt(4)
 v_mfma_f32_32x32x16_bf16 v[40:55], v[200:203], v[168:171], v[40:55]
 v_mfma_f32_32x32x16_bf16 v[56:71], v[200:203], v[172:175], v[56:71]
 v_mfma_f32_32x32x16_bf16 v[72:87], v[204:207], v[168:171], v[72:87]
 v_mfma_f32_32x32x16_bf16 v[88:103], v[204:207], v[172:175], v[88:103]
 s_waitcnt vmcnt(4)
 v_cmp_ne_u32 vcc, s60, v36
 s_cbranch_vccz L_ordy
 s_mov_b32 s43, 0x40000
L_pl25:
 buffer_load_dword v9, v33, s[12:15], s55 offen offset:0 sc1
 s_waitcnt vmcnt(0)
 v_cmp_ne_u32 vcc, s60, v9
 s_sub_u32 s43, s43, 1
 s_cbranch_scc1 L_pd25
 s_cbranch_vccz L_pd25
 s_mov_b64 exec, vcc
 s_sleep 2
 s_branch L_pl25
L_pd25:
 s_mov_b64 exec, -1
L_ordy:
 buffer_load_dwordx4 v[216:219], v12, s[12:15], s53 offen offset:0 sc1
 buffer_load_dwordx4 v[220:223], v13, s[12:15], s53 offen offset:0 sc1
 s_add_u32 s53, s53, 2048
 buffer_load_dwordx4 v[224:227], v12, s[12:15], s53 offen offset:0 sc1
 buffer_load_dwordx4 v[228:231], v13, s[12:15], s53 offen offset:0 sc1
 s_add_u32 s53, s53, 2048
 buffer_load_dwordx4 v[232:235], v12, s[12:15], s53 offen offset:0 sc1
 buffer_load_dwordx4 v[236:239], v13, s[12:15], s53 offen offset:0 sc1
 s_add_u32 s53, s53, 2048
 buffer_load_dwordx4 v[240:243], v12, s[12:15], s53 offen offset:0 sc1
 buffer_load_dwordx4 v[244:247], v13, s[12:15], s53 offen offset:0 sc1
 s_add_u32 s53, s53, 2048
 buffer_load_dwordx4 v[184:187], v12, s[12:15], s53 offen offset:0 sc1
 buffer_load_dwordx4 v[188:191], v13, s[12:15], s53 offen offset:0 sc1
 s_add_u32 s53, s53, 2048
 buffer_load_dwordx4 v[192:195], v12, s[12:15], s53 offen offset:0 sc1
 buffer_load_dwordx4 v[196:199], v13, s[12:15], s53 offen offset:0 sc1
 s_add_u32 s53, s53, 2048
 buffer_load_dwordx4 v[200:203], v12, s[12:15], s53 offen offset:0 sc1
 buffer_load_dwordx4 v[204:207], v13, s[12:15], s53 offen offset:0 sc1
 s_add_u32 s53, s53, 2048
 s_add_u32 m0, s48, 6144
 s_nop 0
 buffer_load_dwordx4 v18, s[24:27], s52 offen offset:0  lds
 buffer_load_dwordx4 v19, s[24:27], s52 offen offset:1024  lds
 s_add_u32 s52, s52, 14336
 ds_read_b64_tr_b16 v[168:169], v20 offset:8192
 ds_read_b64_tr_b16 v[170:171], v20 offset:9216
 ds_read_b64_tr_b16 v[172:173], v21 offset:8192
 ds_read_b64_tr_b16 v[174:175], v21 offset:9216
 s_waitcnt lgkmcnt(4)
 v_mfma_f32_32x32x16_bf16 v[40:55], v[208:211], v[176:179], v[40:55]
 s_add_u32 m0, s48, 8192
 s_nop 0
 buffer_load_dwordx4 v18, s[24:27], s52 offen offset:0  lds
 v_mfma_f32_32x32x16_bf16 v[56:71], v[208:211], v[180:183], v[56:71]
 buffer_load_dwordx4 v19, s[24:27], s52 offen offset:1024  lds
 v_mfma_f32_32x32x16_bf16 v[72:87], v[212:215], v[176:179], v[72:87]
 s_add_u32 s52, s52, 14336
 v_mfma_f32_32x32x16_bf16 v[88:103], v[212:215], v[180:183], v[88:103]
 s_setprio 2
 v_sub_f32 v36, 1.0, v29
 v_sub_f32 v37, 1.0, v30
 v_lshlrev_b32 v30, 16, v31
 v_pk_add_f32 v[40:41], v[40:41], v[30:31] op_sel_hi:[1,0]
 v_pk_add_f32 v[42:43], v[42:43], v[30:31] op_sel_hi:[1,0]
 v_pk_add_f32 v[44:45], v[44:45], v[30:31] op_sel_hi:[1,0]
 v_pk_add_f32 v[46:47], v[46:47], v[30:31] op_sel_hi:[1,0]
 v_pk_add_f32 v[48:49], v[48:49], v[30:31] op_sel_hi:[1,0]
 v_pk_add_f32 v[50:51], v[50:51], v[30:31] op_sel_hi:[1,0]
 v_pk_add_f32 v[52:53], v[52:53], v[30:31] op_sel_hi:[1,0]
 v_pk_add_f32 v[54:55], v[54:55], v[30:31] op_sel_hi:[1,0]
 v_pk_mul_f32 v[40:41], v[40:41], v[36:37] op_sel:[0,0] op_sel_hi:[1,0]
 v_pk_mul_f32 v[42:43], v[42:43], v[36:37] op_sel:[0,0] op_sel_hi:[1,0]
 v_pk_mul_f32 v[44:45], v[44:45], v[36:37] op_sel:[0,0] op_sel_hi:[1,0]
 v_pk_mul_f32 v[46:47], v[46:47], v[36:37] op_sel:[0,0] op_sel_hi:[1,0]
 v_pk_mul_f32 v[48:49], v[48:49], v[36:37] op_sel:[0,0] op_sel_hi:[1,0]
 v_pk_mul_f32 v[50:51], v[50:51], v[36:37] op_sel:[0,0] op_sel_hi:[1,0]
 v_pk_mul_f32 v[52:53], v[52:53], v[36:37] op_sel:[0,0] op_sel_hi:[1,0]
 v_pk_mul_f32 v[54:55], v[54:55], v[36:37] op_sel:[0,0] op_sel_hi:[1,0]
 v_pk_mul_f32 v[56:57], v[56:57], v[36:37] op_sel:[0,1] op_sel_hi:[1,1]
 v_pk_mul_f32 v[58:59], v[58:59], v[36:37] op_sel:[0,1] op_sel_hi:[1,1]
 v_pk_mul_f32 v[60:61], v[60:61], v[36:37] op_sel:[0,1] op_sel_hi:[1,1]
 v_pk_mul_f32 v[62:63], v[62:63], v[36:37] op_sel:[0,1] op_sel_hi:[1,1]
 v_pk_mul_f32 v[64:65], v[64:65], v[36:37] op_sel:[0,1] op_sel_hi:[1,1]
 v_pk_mul_f32 v[66:67], v[66:67], v[36:37] op_sel:[0,1] op_sel_hi:[1,1]
 v_pk_mul_f32 v[68:69], v[68:69], v[36:37] op_sel:[0,1] op_sel_hi:[1,1]
 v_pk_mul_f32 v[70:71], v[70:71], v[36:37] op_sel:[0,1] op_sel_hi:[1,1]
 v_pk_mul_f32 v[72:73], v[72:73], v[36:37] op_sel:[0,0] op_sel_hi:[1,0]
 v_pk_mul_f32 v[74:75], v[74:75], v[36:37] op_sel:[0,0] op_sel_hi:[1,0]
 v_pk_mul_f32 v[76:77], v[76:77], v[36:37] op_sel:[0,0] op_sel_hi:[1,0]
 v_pk_mul_f32 v[78:79], v[78:79], v[36:37] op_sel:[0,0] op_sel_hi:[1,0]
 v_pk_mul_f32 v[80:81], v[80:81], v[36:37] op_sel:[0,0] op_sel_hi:[1,0]
 v_pk_mul_f32 v[82:83], v[82:83], v[36:37] op_sel:[0,0] op_sel_hi:[1,0]
 v_pk_mul_f32 v[84:85], v[84:85], v[36:37] op_sel:[0,0] op_sel_hi:[1,0]
 v_pk_mul_f32 v[86:87], v[86:87], v[36:37] op_sel:[0,0] op_sel_hi:[1,0]
 v_pk_mul_f32 v[88:89], v[88:89], v[36:37] op_sel:[0,1] op_sel_hi:[1,1]
 v_pk_mul_f32 v[90:91], v[90:91], v[36:37] op_sel:[0,1] op_sel_hi:[1,1]
 v_pk_mul_f32 v[92:93], v[92:93], v[36:37] op_sel:[0,1] op_sel_hi:[1,1]
 v_pk_mul_f32 v[94:95], v[94:95], v[36:37] op_sel:[0,1] op_sel_hi:[1,1]
 v_pk_mul_f32 v[96:97], v[96:97], v[36:37] op_sel:[0,1] op_sel_hi:[1,1]
 v_pk_mul_f32 v[98:99], v[98:99], v[36:37] op_sel:[0,1] op_sel_hi:[1,1]
 v_pk_mul_f32 v[100:101], v[100:101], v[36:37] op_sel:[0,1] op_sel_hi:[1,1]
 v_pk_mul_f32 v[102:103], v[102:103], v[36:37] op_sel:[0,1] op_sel_hi:[1,1]
 s_waitcnt vmcnt(16)
 ds_read_b64_tr_b16 v[176:177], v22 offset:0
 ds_read_b64_tr_b16 v[178:179], v22 offset:1024
 ds_read_b64_tr_b16 v[180:181], v23 offset:0
 ds_read_b64_tr_b16 v[182:183], v23 offset:1024
 s_waitcnt lgkmcnt(4)
 v_mfma_f32_32x32x16_bf16 v[40:55], v[168:171], v[216:219], v[40:55]
 s_add_u32 m0, s48, 10240
 s_nop 0
 buffer_load_dwordx4 v18, s[24:27], s52 offen offset:0  lds
 v_mfma_f32_32x32x16_bf16 v[56:71], v[168:171], v[220:223], v[56:71]
 buffer_load_dwordx4 v19, s[24:27], s52 offen offset:1024  lds
 v_mfma_f32_32x32x16_bf16 v[72:87], v[172:175], v[216:219], v[72:87]
 s_add_u32 s52, s52, 14336
 v_mfma_f32_32x32x16_bf16 v[88:103], v[172:175], v[220:223], v[88:103]
 s_waitcnt vmcnt(16)
 ds_read_b64_tr_b16 v[168:169], v22 offset:2048
 ds_read_b64_tr_b16 v[170:171], v22 offset:3072
 ds_read_b64_tr_b16 v[172:173], v23 offset:2048
 ds_read_b64_tr_b16 v[174:175], v23 offset:3072
 s_waitcnt lgkmcnt(4)
 v_mfma_f32_32x32x16_bf16 v[40:55], v[176:179], v[224:227], v[40:55]
 v_mfma_f32_32x32x16_bf16 v[56:71], v[176:179], v[228:231], v[56:71]
 v_mfma_f32_32x32x16_bf16 v[72:87], v[180:183], v[224:227], v[72:87]
 v_mfma_f32_32x32x16_bf16 v[88:103], v[180:183], v[228:231], v[88:103]
 s_waitcnt vmcnt(14)
 ds_read_b64_tr_b16 v[176:177], v22 offset:4096
 ds_read_b64_tr_b16 v[178:179], v22 offset:5120
 ds_read_b64_tr_b16 v[180:181], v23 offset:4096
 ds_read_b64_tr_b16 v[182:183], v23 offset:5120
 s_waitcnt lgkmcnt(4)
 v_mfma_f32_32x32x16_bf16 v[40:55], v[168:171], v[232:235], v[40:55]
 v_mfma_f32_32x32x16_bf16 v[56:71], v[168:171], v[236:239], v[56:71]
 v_mfma_f32_32x32x16_bf16 v[72:87], v[172:175], v[232:235], v[72:87]
 v_mfma_f32_32x32x16_bf16 v[88:103], v[172:175], v[236:239], v[88:103]
 s_waitcnt vmcnt(4)
 ds_read_b64_tr_b16 v[168:169], v22 offset:6144
 ds_read_b64_tr_b16 v[170:171], v22 offset:7168
 ds_read_b64_tr_b16 v[172:173], v23 offset:6144
 ds_read_b64_tr_b16 v[174:175], v23 offset:7168
 s_waitcnt lgkmcnt(4)
 v_mfma_f32_32x32x16_bf16 v[40:55], v[176:179], v[240:243], v[40:55]
 v_mfma_f32_32x32x16_bf16 v[56:71], v[176:179], v[244:247], v[56:71]
 v_mfma_f32_32x32x16_bf16 v[72:87], v[180:183], v[240:243], v[72:87]
 v_mfma_f32_32x32x16_bf16 v[88:103], v[180:183], v[244:247], v[88:103]
 s_waitcnt vmcnt(2)
 ds_read_b64_tr_b16 v[176:177], v22 offset:8192
 ds_read_b64_tr_b16 v[178:179], v22 offset:9216
 ds_read_b64_tr_b16 v[180:181], v23 offset:8192
 ds_read_b64_tr_b16 v[182:183], v23 offset:9216
 s_waitcnt lgkmcnt(4)
 v_mfma_f32_32x32x16_bf16 v[40:55], v[168:171], v[184:187], v[40:55]
 v_mfma_f32_32x32x16_bf16 v[56:71], v[168:171], v[188:191], v[56:71]
 v_mfma_f32_32x32x16_bf16 v[72:87], v[172:175], v[184:187], v[72:87]
 v_mfma_f32_32x32x16_bf16 v[88:103], v[172:175], v[188:191], v[88:103]
 s_waitcnt vmcnt(0)
 ds_read_b64_tr_b16 v[168:169], v22 offset:10240
 ds_read_b64_tr_b16 v[170:171], v22 offset:11264
 ds_read_b64_tr_b16 v[172:173], v23 offset:10240
 ds_read_b64_tr_b16 v[174:175], v23 offset:11264
 s_waitcnt lgkmcnt(4)
 v_mfma_f32_32x32x16_bf16 v[40:55], v[176:179], v[192:195], v[40:55]
 v_mfma_f32_32x32x16_bf16 v[56:71], v[176:179], v[196:199], v[56:71]
 v_mfma_f32_32x32x16_bf16 v[72:87], v[180:183], v[192:195], v[72:87]
 v_mfma_f32_32x32x16_bf16 v[88:103], v[180:183], v[196:199], v[88:103]
 s_waitcnt lgkmcnt(0)
 v_mfma_f32_32x32x16_bf16 v[40:55], v[168:171], v[200:203], v[40:55]
 v_mfma_f32_32x32x16_bf16 v[56:71], v[168:171], v[204:207], v[56:71]
 v_mfma_f32_32x32x16_bf16 v[72:87], v[172:175], v[200:203], v[72:87]
 v_mfma_f32_32x32x16_bf16 v[88:103], v[172:175], v[204:207], v[88:103]
 s_setprio 2
 s_mul_i32 s41, s5, 14336
 s_add_u32 s41, s41, 0
 v_lshl_add_u32 v7, v1, 4, s41
 s_nop 5
 ds_write_b128 v7, v[56:59] offset:0
 ds_write_b128 v7, v[60:63] offset:1024
 ds_write_b128 v7, v[64:67] offset:2048
 ds_write_b128 v7, v[68:71] offset:3072
 ds_write_b128 v7, v[72:75] offset:4096
 ds_write_b128 v7, v[76:79] offset:5120
 ds_write_b128 v7, v[80:83] offset:6144
 ds_write_b128 v7, v[84:87] offset:7168
 ds_write_b128 v7, v[88:91] offset:8192
 ds_write_b128 v7, v[92:95] offset:9216
 ds_write_b128 v7, v[96:99] offset:10240
 ds_write_b128 v7, v[100:103] offset:11264
 s_waitcnt lgkmcnt(0)
 s_mov_b64 exec, 1
 v_mov_b32 v8, 162844
 v_mov_b32 v9, 1
 ds_add_u32 v8, v9
 s_mov_b64 exec, -1
 v_mov_b32 v8, 162844
 s_mov_b32 s43, 0x400000
L_ll26:
 ds_read_b32 v9, v8
 s_waitcnt lgkmcnt(0)
 v_cmp_gt_u32 vcc, 4, v9
 s_sub_u32 s43, s43, 1
 s_cbranch_scc1 L_ld26
 s_cbranch_vccz L_ld26
 s_sleep 1
 s_branch L_ll26
L_ld26:
 s_xor_b32 s41, s5, 1
 s_mul_i32 s41, s41, 14336
 s_add_u32 s41, s41, 0
 v_lshl_add_u32 v7, v1, 4, s41
 ds_read_b128 v[56:59], v7 offset:0
 ds_read_b128 v[60:63], v7 offset:1024
 ds_read_b128 v[64:67], v7 offset:2048
 ds_read_b128 v[68:71], v7 offset:3072
 s_xor_b32 s41, s5, 2
 s_mul_i32 s41, s41, 14336
 s_add_u32 s41, s41, 0
 v_lshl_add_u32 v7, v1, 4, s41
 ds_read_b128 v[72:75], v7 offset:4096
 ds_read_b128 v[76:79], v7 offset:5120
 ds_read_b128 v[80:83], v7 offset:6144
 ds_read_b128 v[84:87], v7 offset:7168
 s_xor_b32 s41, s5, 3
 s_mul_i32 s41, s41, 14336
 s_add_u32 s41, s41, 0
 v_lshl_add_u32 v7, v1, 4, s41
 ds_read_b128 v[88:91], v7 offset:8192
 ds_read_b128 v[92:95], v7 offset:9216
 ds_read_b128 v[96:99], v7 offset:10240
 ds_read_b128 v[100:103], v7 offset:11264
 s_waitcnt lgkmcnt(8)
 v_pk_add_f32 v[40:41], v[40:41], v[56:57]
 v_pk_add_f32 v[42:43], v[42:43], v[58:59]
 v_pk_add_f32 v[44:45], v[44:45], v[60:61]
 v_pk_add_f32 v[46:47], v[46:47], v[62:63]
 v_pk_add_f32 v[48:49], v[48:49], v[64:65]
 v_pk_add_f32 v[50:51], v[50:51], v[66:67]
 v_pk_add_f32 v[52:53], v[52:53], v[68:69]
 v_pk_add_f32 v[54:55], v[54:55], v[70:71]
 s_waitcnt lgkmcnt(4)
 v_pk_add_f32 v[40:41], v[40:41], v[72:73]
 v_pk_add_f32 v[42:43], v[42:43], v[74:75]
 v_pk_add_f32 v[44:45], v[44:45], v[76:77]
 v_pk_add_f32 v[46:47], v[46:47], v[78:79]
 v_pk_add_f32 v[48:49], v[48:49], v[80:81]
 v_pk_add_f32 v[50:51], v[50:51], v[82:83]
 v_pk_add_f32 v[52:53], v[52:53], v[84:85]
 v_pk_add_f32 v[54:55], v[54:55], v[86:87]
 s_waitcnt lgkmcnt(0)
 v_pk_add_f32 v[40:41], v[40:41], v[88:89]
 v_pk_add_f32 v[42:43], v[42:43], v[90:91]
 v_pk_add_f32 v[44:45], v[44:45], v[92:93]
 v_pk_add_f32 v[46:47], v[46:47], v[94:95]
 v_pk_add_f32 v[48:49], v[48:49], v[96:97]
 v_pk_add_f32 v[50:51], v[50:51], v[98:99]
 v_pk_add_f32 v[52:53], v[52:53], v[100:101]
 v_pk_add_f32 v[54:55], v[54:55], v[102:103]
 v_mul_u32_u24 v7, 896, v28
 v_lshl_add_u32 v7, v2, 4, v7
 s_lshl_b32 s36, s4, 1
 s_add_u32 s36, s36, s6
 s_lshl_b32 s36, s36, 6
 v_cvt_pk_bf16_f32 v104, v40, v41
 v_cvt_pk_bf16_f32 v105, v42, v43
 v_cvt_pk_bf16_f32 v106, v44, v45
 v_cvt_pk_bf16_f32 v107, v46, v47
 s_nop 0
 v_permlane32_swap_b32 v104, v106
 v_permlane32_swap_b32 v105, v107
 buffer_store_dwordx4 v[104:107], v7, s[32:35], s36 offen offset:0
 v_cvt_pk_bf16_f32 v108, v48, v49
 v_cvt_pk_bf16_f32 v109, v50, v51
 v_cvt_pk_bf16_f32 v110, v52, v53
 v_cvt_pk_bf16_f32 v111, v54, v55
 s_nop 0
 v_permlane32_swap_b32 v108, v110
 v_permlane32_swap_b32 v109, v111
 buffer_store_dwordx4 v[108:111], v7, s[32:35], s36 offen offset:32
L_end:
 s_waitcnt vmcnt(0)
 s_endpgm
.section .rodata,"a"
.p2align 6
.amdhsa_kernel gated_mix__grouped_kv_mqa__mixer_token_mlp__prompt_kernel
  .amdhsa_next_free_vgpr 256
  .amdhsa_next_free_sgpr 102
  .amdhsa_accum_offset 256
  .amdhsa_group_segment_fixed_size 0
  .amdhsa_kernarg_size 112
  .amdhsa_user_sgpr_count 2
  .amdhsa_user_sgpr_kernarg_segment_ptr 1
  .amdhsa_system_sgpr_workgroup_id_x 1
.end_amdhsa_kernel
```
